```python
import torch

def _softmax(x, axis=-1):
    return torch.softmax(x, dim=axis)
def _gelu(x):
    return torch.nn.functional.gelu(x, approximate="tanh")
def _silu(x):
    return torch.nn.functional.silu(x)
def _sigmoid(x):
    return torch.sigmoid(x)
def _layernorm(x, axis=-1, eps=1e-5):
    m = x.mean(dim=axis, keepdim=True)
    v = x.var(dim=axis, keepdim=True, unbiased=False)
    return (x - m) / torch.sqrt(v + eps)
def _scatter_add(tgt, idx, src, axis=0):
    return tgt.clone().index_add_(axis, idx, src)
def _segment_sum(src, seg, n):
    out = torch.zeros((n,) + src.shape[1:], dtype=src.dtype)
    return out.index_add_(0, seg, src)
def _pad(x, pw):
    flat = tuple(v for pair in reversed(pw) for v in pair)
    return torch.nn.functional.pad(x, flat)

kernel_name = 'parallel_sum__gqa_block_cached__swiglu_ffn__decode'

def setup_inputs():

    _w = (lambda a: (lambda t: t.to(torch.bfloat16) if t.is_floating_point() else t)(torch.as_tensor(a)))
    def _A_setup():
        B, Sq, D = 1, 1, 448
        Hq, Hkv, Sk, Dh = 16, 8, 32768, 256
        assert Hq % Hkv == 0, (Hq, Hkv)
        return {
            "x": _w((lambda *s: torch.randn(*s, dtype=torch.bfloat16) * 0.05)(B, Sq, D)),
            "k_cache": _w((lambda *s: torch.randn(*s, dtype=torch.bfloat16) * 3.2)(B, Hkv, Sk, Dh)),
            "v_cache": _w((lambda *s: torch.randn(*s, dtype=torch.bfloat16) * 1.6)(B, Hkv, Sk, Dh)),
            "wq": _w((lambda *s: torch.randn(*s, dtype=torch.bfloat16) * 3.2)(D, Hq * Dh) * (D ** -0.5)),
            "wo": _w((lambda *s: torch.randn(*s, dtype=torch.bfloat16) * 1.6)(Hq * Dh, D) * ((Hq * Dh) ** -0.5)),
        }
    _A_in = _A_setup()

    def _B_setup():
        B, S, D, F = 1, 1, 448, 1792
        return {
            "x": _w((lambda *s: torch.randn(*s, dtype=torch.bfloat16) * 0.05)(B, S, D)),
            "w_gate": _w((lambda *s: torch.randn(*s, dtype=torch.bfloat16) * 0.05)(D, F)),
            "w_up": _w((lambda *s: torch.randn(*s, dtype=torch.bfloat16) * 0.05)(D, F)),
            "w_down": _w((lambda *s: torch.randn(*s, dtype=torch.bfloat16) * 0.05)(F, D)),
        }
    _B_in = _B_setup()

    return {
        "A_x": _A_in["x"],
        "A_k_cache": _A_in["k_cache"],
        "A_v_cache": _A_in["v_cache"],
        "A_wq": _A_in["wq"],
        "A_wo": _A_in["wo"],
        "B_x": _B_in["x"],
        "B_w_gate": _B_in["w_gate"],
        "B_w_up": _B_in["w_up"],
        "B_w_down": _B_in["w_down"],
    }

def reference(A_x, A_k_cache, A_v_cache, A_wq, A_wo, B_x, B_w_gate, B_w_up, B_w_down):
    def _A_ref(x, k_cache, v_cache, wq, wo):
        B, Sq, D = x.shape
        Hq, Dh = 16, 256
        Hkv = k_cache.shape[1]
        rep = Hq // Hkv
        q = (lambda x, *d: x.permute(*d))((x @ wq).reshape(B, Sq, Hq, Dh), 0, 2, 1, 3)
        k = (lambda x, n, axis: torch.repeat_interleave(x, n, dim=axis))(k_cache, rep, axis=1)
        v = (lambda x, n, axis: torch.repeat_interleave(x, n, dim=axis))(v_cache, rep, axis=1)
        scores = torch.einsum("bhqd,bhkd->bhqk", q, k) * (Dh ** -0.5)
        p = _softmax(scores, axis=-1)
        o = torch.einsum("bhqk,bhkd->bhqd", p, v)
        return (lambda x, *d: x.permute(*d))(o, 0, 2, 1, 3).reshape(B, Sq, Hq * Dh) @ wo

    def _B_ref(x, w_gate, w_up, w_down):
        g = _silu(x @ w_gate)
        u = x @ w_up
        return (g * u) @ w_down

    x = A_x
    xn = _layernorm(x, axis=-1)
    return x + _A_ref(xn, A_k_cache, A_v_cache, A_wq, A_wo) + _B_ref(xn, B_w_gate, B_w_up, B_w_down)
```

```asm
; @launch grid=(256,1,1) block=(512,1,1) lds=43200
.amdgcn_target "amdgcn-amd-amdhsa--gfx950"
.text
.globl parallel_sum__gqa_block_cached__swiglu_ffn__decode_kernel
.p2align 8
.type parallel_sum__gqa_block_cached__swiglu_ffn__decode_kernel,@function
parallel_sum__gqa_block_cached__swiglu_ffn__decode_kernel:
s_cmp_ge_u32 s2, 256
s_cbranch_scc1 .Ldone
s_load_dwordx16 s[16:31], s[0:1], 0
s_load_dwordx8 s[32:39], s[0:1], 64
s_memrealtime s[90:91]
v_lshrrev_b32 v1, 6, v0
v_and_b32 v0, 63, v0
v_readfirstlane_b32 s3, v1
s_lshr_b32 s4, s2, 5
s_and_b32 s5, s2, 31
s_mov_b32 s8, 0x05040100
s_mov_b32 s9, 0x07060302
s_mov_b32 s10, 0x3db8aa3b
s_cmp_eq_u32 s3, 0
s_cbranch_scc1 .Lhelper
s_sub_u32 s6, s3, 1
v_lshrrev_b32 v2, 4, v0
v_and_b32 v3, 15, v0
v_lshlrev_b32 v3, 4, v3
v_lshl_add_u32 v1, v2, 12, v3
s_lshl_b32 s11, s2, 19
s_mov_b32 s99, s6
s_and_b32 s60, s99, 1
s_lshr_b32 s13, s99, 1
s_lshl_b32 s13, s13, 14
s_lshl_b32 s60, s60, 11
s_add_u32 s13, s13, s60
s_add_u32 s13, s13, s11
s_waitcnt lgkmcnt(0)
s_mov_b32 s40, s18
s_mov_b32 s41, s19
s_mov_b32 s42, 0x8000000
s_mov_b32 s43, 0x20000
s_mov_b32 s44, s18
s_mov_b32 s45, s19
s_mov_b32 s46, 0x8000000
s_mov_b32 s47, 0x20000
buffer_load_dwordx4 v[80:83], v1, s[40:43], s13 offen offset:0 nt
buffer_load_dwordx4 v[84:87], v1, s[40:43], s13 offen offset:256 nt
buffer_load_dwordx4 v[88:91], v1, s[40:43], s13 offen offset:512 nt
buffer_load_dwordx4 v[92:95], v1, s[40:43], s13 offen offset:768 nt
v_mov_b32 v79, 0
s_mov_b32 s48, s38
s_mov_b32 s49, s39
s_mov_b32 s50, 0x260000
s_mov_b32 s51, 0x20000
s_cmp_eq_u32 s3, 7
s_cselect_b32 s56, 0, 1
s_or_b32 s56, s56, s2
s_cmp_eq_u32 s56, 0
s_cbranch_scc0 .Lnoep
s_mov_b32 s52, s36
s_mov_b32 s53, s37
s_mov_b32 s54, 0x100
s_mov_b32 s55, 0x20000
s_or_b32 s56, s90, 1
v_mov_b32 v4, s56
s_mov_b64 exec, 1
buffer_store_dword v4, v79, s[52:55], 0 offen sc1
s_mov_b64 exec, -1
.Lnoep:
v_mov_b32 v4, -1
v_mov_b32 v5, -1
v_mov_b32 v6, -1
v_mov_b32 v7, -1
s_lshl_b32 s56, s3, 10
v_lshl_add_u32 v8, v0, 4, s56
ds_write_b128 v8, v[4:7] offset:2240
s_cmp_eq_u32 s3, 1
s_cbranch_scc0 .Lnoinit
ds_write_b128 v8, v[4:7] offset:1216
v_mov_b32 v4, 28
v_mov_b32 v5, 0
v_mov_b32 v6, 0
v_mov_b32 v7, 0
ds_write_b128 v79, v[4:7] offset:1408
ds_write_b32 v79, v5 offset:1424
v_mov_b32 v4, 0xf149f2ca
v_mov_b32 v5, v4
ds_write_b128 v79, v[4:7] offset:1440
.Lnoinit:
s_waitcnt lgkmcnt(0)
s_barrier
s_lshr_b32 s7, s2, 3
s_lshl_b32 s12, s7, 22
s_add_u32 s56, s7, 3
s_and_b32 s56, s56, 7
s_lshl_b32 s15, s56, 19
s_add_u32 s15, s15, s12
s_and_b32 s14, s2, 7
s_cmp_eq_u32 s14, s56
s_cselect_b32 s14, 28, 48
s_cmp_lt_u32 s7, 28
s_cselect_b32 s14, s14, 48
s_mov_b32 s101, 128
s_cselect_b32 s101, 148, s101
s_lshl_b32 s83, s7, 14
s_add_u32 s83, s83, 1966080
s_mul_i32 s7, s7, 4352
s_cmp_lt_u32 s6, 4
s_cselect_b32 s100, 1, 0
s_mov_b32 s84, 0
s_mov_b32 s75, 0x10000000
s_mov_b32 s80, 0x00010001
s_mov_b32 s81, 0x00010001
v_lshlrev_b32 v237, 4, v2
s_sub_u32 s52, s6, 3
s_and_b32 s56, s52, 1
s_lshr_b32 s52, s52, 1
v_lshlrev_b32 v8, 4, v0
v_and_b32 v12, 3, v0
v_and_b32 v15, 31, v0
v_lshrrev_b32 v11, 5, v0
v_lshrrev_b32 v9, 2, v15
v_lshlrev_b32 v9, 11, v9
v_lshl_add_u32 v9, v12, 4, v9
v_and_b32 v14, 1, v0
v_lshlrev_b32 v14, 4, v14
s_lshl_b32 s57, s4, 1
s_add_u32 s57, s57, s56
s_lshl_b32 s57, s57, 15
s_lshl_b32 s58, s52, 14
s_add_u32 s57, s57, s58
s_lshl_b32 s58, s5, 6
s_add_u32 s57, s57, s58
s_add_u32 s57, s57, 262144
v_lshrrev_b32 v10, 1, v15
v_lshlrev_b32 v10, 4, v10
v_lshl_add_u32 v10, v11, 9, v10
v_and_b32 v13, 1, v15
v_lshl_add_u32 v10, v13, 10, v10
s_lshl_b32 s58, s56, 12
s_lshl_b32 s59, s52, 11
s_add_u32 s58, s58, s59
v_add_u32 v10, s58, v10
v_bfe_u32 v16, v0, 3, 1
v_xor_b32 v16, v16, v11
v_and_b32 v17, 1, v0
v_lshl_add_u32 v16, v16, 1, v17
v_lshlrev_b32 v16, 4, v16
v_bfe_u32 v17, v0, 1, 2
v_lshl_add_u32 v18, v17, 6, v16
v_add_u32 v18, 1472, v18
v_mov_b32 v19, 1440
v_cmp_le_u32 vcc, 4, v17
s_nop 1
v_cndmask_b32 v15, v18, v19, vcc
s_lshl_b32 s58, s56, 2
v_add_u32 v15, s58, v15
v_mov_b32 v244, v9
v_mov_b32 v245, v10
v_mov_b32 v246, v14
v_mov_b32 v247, v15
s_mov_b32 s82, s57
v_mov_b32 v32, 0
v_mov_b32 v33, 0
v_mov_b32 v34, 0
v_mov_b32 v35, 0
v_mov_b32 v36, 0
v_mov_b32 v37, 0
v_mov_b32 v38, 0
v_mov_b32 v39, 0
v_mov_b32 v40, 0
v_mov_b32 v41, 0
v_mov_b32 v42, 0
v_mov_b32 v43, 0
v_mov_b32 v44, 0
v_mov_b32 v45, 0
v_mov_b32 v46, 0
v_mov_b32 v47, 0
v_mov_b32 v48, 0
v_mov_b32 v49, 0
v_mov_b32 v50, 0
v_mov_b32 v51, 0
v_mov_b32 v52, 0
v_mov_b32 v53, 0
v_mov_b32 v54, 0
v_mov_b32 v55, 0
v_mov_b32 v56, 0
v_mov_b32 v57, 0
v_mov_b32 v58, 0
v_mov_b32 v59, 0
v_mov_b32 v60, 0
v_mov_b32 v61, 0
v_mov_b32 v62, 0
v_mov_b32 v63, 0
v_mov_b32 v8, 0xf149f2ca
v_mov_b32 v10, 0
v_mov_b32 v12, 0
v_mov_b32 v9, 0xf149f2ca
v_mov_b32 v11, 0
v_mov_b32 v13, 0
s_mov_b32 s64, 0
s_mov_b32 s68, s99
s_waitcnt vmcnt(0)
buffer_load_dwordx4 v[96:99], v1, s[44:47], s13 offen offset:1024 nt
buffer_load_dwordx4 v[100:103], v1, s[44:47], s13 offen offset:1280 nt
buffer_load_dwordx4 v[104:107], v1, s[44:47], s13 offen offset:1536 nt
buffer_load_dwordx4 v[108:111], v1, s[44:47], s13 offen offset:1792 nt
s_add_u32 s99, s99, 7
s_and_b32 s60, s99, 1
s_lshr_b32 s13, s99, 1
s_lshl_b32 s13, s13, 14
s_lshl_b32 s60, s60, 11
s_add_u32 s13, s13, s60
s_add_u32 s13, s13, s11
s_waitcnt vmcnt(0)
buffer_load_dwordx4 v[112:115], v1, s[40:43], s13 offen offset:0 nt
buffer_load_dwordx4 v[116:119], v1, s[40:43], s13 offen offset:256 nt
buffer_load_dwordx4 v[120:123], v1, s[40:43], s13 offen offset:512 nt
buffer_load_dwordx4 v[124:127], v1, s[40:43], s13 offen offset:768 nt
s_mov_b32 s65, 0
s_mov_b32 s69, s99
s_waitcnt vmcnt(0)
buffer_load_dwordx4 v[128:131], v1, s[44:47], s13 offen offset:1024 nt
buffer_load_dwordx4 v[132:135], v1, s[44:47], s13 offen offset:1280 nt
buffer_load_dwordx4 v[136:139], v1, s[44:47], s13 offen offset:1536 nt
buffer_load_dwordx4 v[140:143], v1, s[44:47], s13 offen offset:1792 nt
s_add_u32 s99, s99, 7
s_and_b32 s60, s99, 1
s_lshr_b32 s13, s99, 1
s_lshl_b32 s13, s13, 14
s_lshl_b32 s60, s60, 11
s_add_u32 s13, s13, s60
s_add_u32 s13, s13, s11
s_waitcnt vmcnt(0)
buffer_load_dwordx4 v[144:147], v1, s[40:43], s13 offen offset:0 nt
buffer_load_dwordx4 v[148:151], v1, s[40:43], s13 offen offset:256 nt
buffer_load_dwordx4 v[152:155], v1, s[40:43], s13 offen offset:512 nt
buffer_load_dwordx4 v[156:159], v1, s[40:43], s13 offen offset:768 nt
s_mov_b32 s66, 0
s_mov_b32 s70, s99
s_waitcnt vmcnt(0)
buffer_load_dwordx4 v[160:163], v1, s[44:47], s13 offen offset:1024 nt
buffer_load_dwordx4 v[164:167], v1, s[44:47], s13 offen offset:1280 nt
buffer_load_dwordx4 v[168:171], v1, s[44:47], s13 offen offset:1536 nt
buffer_load_dwordx4 v[172:175], v1, s[44:47], s13 offen offset:1792 nt
s_add_u32 s99, s99, 7
s_and_b32 s60, s99, 1
s_lshr_b32 s13, s99, 1
s_lshl_b32 s13, s13, 14
s_lshl_b32 s60, s60, 11
s_add_u32 s13, s13, s60
s_add_u32 s13, s13, s11
s_waitcnt vmcnt(0)
buffer_load_dwordx4 v[176:179], v1, s[40:43], s13 offen offset:0 nt
buffer_load_dwordx4 v[180:183], v1, s[40:43], s13 offen offset:256 nt
buffer_load_dwordx4 v[184:187], v1, s[40:43], s13 offen offset:512 nt
buffer_load_dwordx4 v[188:191], v1, s[40:43], s13 offen offset:768 nt
s_mov_b32 s67, 0
s_mov_b32 s71, s99
s_waitcnt vmcnt(0)
buffer_load_dwordx4 v[192:195], v1, s[44:47], s13 offen offset:1024 nt
buffer_load_dwordx4 v[196:199], v1, s[44:47], s13 offen offset:1280 nt
buffer_load_dwordx4 v[200:203], v1, s[44:47], s13 offen offset:1536 nt
buffer_load_dwordx4 v[204:207], v1, s[44:47], s13 offen offset:1792 nt
s_add_u32 s99, s99, 7
s_and_b32 s60, s99, 1
s_lshr_b32 s13, s99, 1
s_lshl_b32 s13, s13, 14
s_lshl_b32 s60, s60, 11
s_add_u32 s13, s13, s60
s_add_u32 s13, s13, s11
v_mov_b32 v78, 1
s_mov_b32 s57, 1
s_cmp_eq_u32 s100, 0
s_cbranch_scc1 .Lrd2
s_bitcmp1_b32 s84, 0
s_cbranch_scc1 .Lrg1a
v_mov_b32 v76, 1
v_mov_b32 v239, s84
s_mov_b64 exec, 1
ds_add_rtn_u32 v76, v239, v76 offset:1408
ds_read_b32 v77, v79 offset:1412
s_mov_b64 exec, -1
s_waitcnt lgkmcnt(0)
v_readfirstlane_b32 s85, v76
v_readfirstlane_b32 s59, v77
s_and_b32 s60, s85, 1
s_lshr_b32 s56, s85, 1
s_lshl_b32 s56, s56, 14
s_lshl_b32 s60, s60, 11
s_add_u32 s56, s56, s60
s_add_u32 s56, s56, s11
s_lshr_b32 s57, s84, 4
s_cmp_lt_u32 s85, s14
s_cbranch_scc1 .Lrd2
s_or_b32 s84, s84, 1
s_cmp_lg_u32 s59, 0
s_cbranch_scc1 .Lok3
s_mov_b32 s60, 0
.Lsp4:
s_sleep 2
ds_read_b32 v77, v79 offset:1412
s_waitcnt lgkmcnt(0)
v_readfirstlane_b32 s59, v77
s_add_u32 s60, s60, 1
s_cmp_lg_u32 s59, 0
s_cbranch_scc1 .Lok3
s_cmp_lt_u32 s60, 800000
s_cbranch_scc1 .Lsp4
.Lok3:
.Lrg1a:
s_lshr_b32 s57, s84, 4
s_lshl_b32 s58, s57, 7
s_add_u32 s58, s58, s7
s_add_u32 s57, s57, 2
s_mov_b64 exec, 1
buffer_atomic_add v78, v79, s[48:51], s58 offen sc0 sc1
s_mov_b64 exec, -1
s_branch .Lrd2e
.Lrd2:
s_mov_b64 exec, 1
buffer_load_dword v242, v79, s[48:51], s75 offen
s_mov_b64 exec, -1
.Lrd2e:
s_cmp_eq_u32 s100, 0
s_cbranch_scc1 .Lnoprio
s_setprio 1
.Lnoprio:
ds_read_b32 v77, v79 offset:1416
s_waitcnt lgkmcnt(0)
v_readfirstlane_b32 s59, v77
s_cmp_lg_u32 s59, 0
s_cbranch_scc1 .Lok5
s_mov_b32 s60, 0
.Lsp6:
s_sleep 2
ds_read_b32 v77, v79 offset:1416
s_waitcnt lgkmcnt(0)
v_readfirstlane_b32 s59, v77
s_add_u32 s60, s60, 1
s_cmp_lg_u32 s59, 0
s_cbranch_scc1 .Lok5
s_cmp_lt_u32 s60, 800000
s_cbranch_scc1 .Lsp6
.Lok5:
ds_read_b128 v[16:19], v3 offset:0
ds_read_b128 v[20:23], v3 offset:256
ds_read_b128 v[24:27], v3 offset:512
ds_read_b128 v[28:31], v3 offset:768
s_lshl_b32 s60, s6, 13
v_lshl_add_u32 v240, v0, 4, s60
s_lshl_b32 s60, s6, 6
v_add_u32 v241, s60, v237
s_waitcnt lgkmcnt(0)
s_lshl_b32 s60, s70, 6
v_add_u32 v236, s60, v237
s_waitcnt vmcnt(13)
v_mov_b32 v4, 0
v_mov_b32 v5, 0
v_mov_b32 v6, 0
v_mov_b32 v7, 0
v_dot2c_f32_bf16 v4, v144, v16
v_dot2c_f32_bf16 v5, v144, v24
v_dot2c_f32_bf16 v6, v152, v16
v_dot2c_f32_bf16 v7, v152, v24
v_dot2c_f32_bf16 v4, v148, v20
v_dot2c_f32_bf16 v5, v148, v28
v_dot2c_f32_bf16 v6, v156, v20
v_dot2c_f32_bf16 v7, v156, v28
v_dot2c_f32_bf16 v4, v145, v17
v_dot2c_f32_bf16 v5, v145, v25
v_dot2c_f32_bf16 v6, v153, v17
v_dot2c_f32_bf16 v7, v153, v25
v_dot2c_f32_bf16 v4, v149, v21
v_dot2c_f32_bf16 v5, v149, v29
v_dot2c_f32_bf16 v6, v157, v21
v_dot2c_f32_bf16 v7, v157, v29
v_dot2c_f32_bf16 v4, v146, v18
v_dot2c_f32_bf16 v5, v146, v26
v_dot2c_f32_bf16 v6, v154, v18
v_dot2c_f32_bf16 v7, v154, v26
v_dot2c_f32_bf16 v4, v150, v22
v_dot2c_f32_bf16 v5, v150, v30
v_dot2c_f32_bf16 v6, v158, v22
v_dot2c_f32_bf16 v7, v158, v30
v_dot2c_f32_bf16 v4, v147, v19
v_dot2c_f32_bf16 v5, v147, v27
v_dot2c_f32_bf16 v6, v155, v19
v_dot2c_f32_bf16 v7, v155, v27
v_dot2c_f32_bf16 v4, v151, v23
v_dot2c_f32_bf16 v5, v151, v31
v_dot2c_f32_bf16 v6, v159, v23
v_dot2c_f32_bf16 v7, v159, v31
v_add_f32_dpp v4, v4, v4 quad_perm:[1,0,3,2] row_mask:0xf bank_mask:0xf
v_add_f32_dpp v5, v5, v5 quad_perm:[1,0,3,2] row_mask:0xf bank_mask:0xf
v_add_f32_dpp v6, v6, v6 quad_perm:[1,0,3,2] row_mask:0xf bank_mask:0xf
v_add_f32_dpp v7, v7, v7 quad_perm:[1,0,3,2] row_mask:0xf bank_mask:0xf
v_add_f32_dpp v4, v4, v4 quad_perm:[2,3,0,1] row_mask:0xf bank_mask:0xf
v_add_f32_dpp v5, v5, v5 quad_perm:[2,3,0,1] row_mask:0xf bank_mask:0xf
v_add_f32_dpp v6, v6, v6 quad_perm:[2,3,0,1] row_mask:0xf bank_mask:0xf
v_add_f32_dpp v7, v7, v7 quad_perm:[2,3,0,1] row_mask:0xf bank_mask:0xf
v_add_f32_dpp v4, v4, v4 row_half_mirror row_mask:0xf bank_mask:0xf
v_add_f32_dpp v5, v5, v5 row_half_mirror row_mask:0xf bank_mask:0xf
v_add_f32_dpp v6, v6, v6 row_half_mirror row_mask:0xf bank_mask:0xf
v_add_f32_dpp v7, v7, v7 row_half_mirror row_mask:0xf bank_mask:0xf
v_add_f32_dpp v4, v4, v4 row_mirror row_mask:0xf bank_mask:0xf
v_add_f32_dpp v5, v5, v5 row_mirror row_mask:0xf bank_mask:0xf
v_add_f32_dpp v6, v6, v6 row_mirror row_mask:0xf bank_mask:0xf
v_add_f32_dpp v7, v7, v7 row_mirror row_mask:0xf bank_mask:0xf
v_cvt_pk_bf16_f32 v64, v4, v6
v_cvt_pk_bf16_f32 v65, v5, v7
v_min_u32 v64, -2, v64
v_min_u32 v65, -2, v65
s_mov_b64 exec, s[80:81]
ds_write_b64 v236, v[64:65] offset:2240
s_mov_b64 exec, -1
s_waitcnt vmcnt(9)
v_mov_b32 v4, 0
v_mov_b32 v5, 0
v_mov_b32 v6, 0
v_mov_b32 v7, 0
v_dot2c_f32_bf16 v4, v160, v16
v_dot2c_f32_bf16 v5, v160, v24
v_dot2c_f32_bf16 v6, v168, v16
v_dot2c_f32_bf16 v7, v168, v24
v_dot2c_f32_bf16 v4, v164, v20
v_dot2c_f32_bf16 v5, v164, v28
v_dot2c_f32_bf16 v6, v172, v20
v_dot2c_f32_bf16 v7, v172, v28
v_dot2c_f32_bf16 v4, v161, v17
v_dot2c_f32_bf16 v5, v161, v25
v_dot2c_f32_bf16 v6, v169, v17
v_dot2c_f32_bf16 v7, v169, v25
v_dot2c_f32_bf16 v4, v165, v21
v_dot2c_f32_bf16 v5, v165, v29
v_dot2c_f32_bf16 v6, v173, v21
v_dot2c_f32_bf16 v7, v173, v29
v_dot2c_f32_bf16 v4, v162, v18
v_dot2c_f32_bf16 v5, v162, v26
v_dot2c_f32_bf16 v6, v170, v18
v_dot2c_f32_bf16 v7, v170, v26
v_dot2c_f32_bf16 v4, v166, v22
v_dot2c_f32_bf16 v5, v166, v30
v_dot2c_f32_bf16 v6, v174, v22
v_dot2c_f32_bf16 v7, v174, v30
v_dot2c_f32_bf16 v4, v163, v19
v_dot2c_f32_bf16 v5, v163, v27
v_dot2c_f32_bf16 v6, v171, v19
v_dot2c_f32_bf16 v7, v171, v27
v_dot2c_f32_bf16 v4, v167, v23
v_dot2c_f32_bf16 v5, v167, v31
v_dot2c_f32_bf16 v6, v175, v23
v_dot2c_f32_bf16 v7, v175, v31
v_add_f32_dpp v4, v4, v4 quad_perm:[1,0,3,2] row_mask:0xf bank_mask:0xf
v_add_f32_dpp v5, v5, v5 quad_perm:[1,0,3,2] row_mask:0xf bank_mask:0xf
v_add_f32_dpp v6, v6, v6 quad_perm:[1,0,3,2] row_mask:0xf bank_mask:0xf
v_add_f32_dpp v7, v7, v7 quad_perm:[1,0,3,2] row_mask:0xf bank_mask:0xf
v_add_f32_dpp v4, v4, v4 quad_perm:[2,3,0,1] row_mask:0xf bank_mask:0xf
v_add_f32_dpp v5, v5, v5 quad_perm:[2,3,0,1] row_mask:0xf bank_mask:0xf
v_add_f32_dpp v6, v6, v6 quad_perm:[2,3,0,1] row_mask:0xf bank_mask:0xf
v_add_f32_dpp v7, v7, v7 quad_perm:[2,3,0,1] row_mask:0xf bank_mask:0xf
v_add_f32_dpp v4, v4, v4 row_half_mirror row_mask:0xf bank_mask:0xf
v_add_f32_dpp v5, v5, v5 row_half_mirror row_mask:0xf bank_mask:0xf
v_add_f32_dpp v6, v6, v6 row_half_mirror row_mask:0xf bank_mask:0xf
v_add_f32_dpp v7, v7, v7 row_half_mirror row_mask:0xf bank_mask:0xf
v_add_f32_dpp v4, v4, v4 row_mirror row_mask:0xf bank_mask:0xf
v_add_f32_dpp v5, v5, v5 row_mirror row_mask:0xf bank_mask:0xf
v_add_f32_dpp v6, v6, v6 row_mirror row_mask:0xf bank_mask:0xf
v_add_f32_dpp v7, v7, v7 row_mirror row_mask:0xf bank_mask:0xf
v_cvt_pk_bf16_f32 v64, v4, v6
v_cvt_pk_bf16_f32 v65, v5, v7
v_min_u32 v64, -2, v64
v_min_u32 v65, -2, v65
s_mov_b64 exec, s[80:81]
ds_write_b64 v236, v[64:65] offset:2248
s_mov_b64 exec, -1
s_lshl_b32 s60, s71, 6
v_add_u32 v236, s60, v237
s_waitcnt vmcnt(5)
v_mov_b32 v4, 0
v_mov_b32 v5, 0
v_mov_b32 v6, 0
v_mov_b32 v7, 0
v_dot2c_f32_bf16 v4, v176, v16
v_dot2c_f32_bf16 v5, v176, v24
v_dot2c_f32_bf16 v6, v184, v16
v_dot2c_f32_bf16 v7, v184, v24
v_dot2c_f32_bf16 v4, v180, v20
v_dot2c_f32_bf16 v5, v180, v28
v_dot2c_f32_bf16 v6, v188, v20
v_dot2c_f32_bf16 v7, v188, v28
v_dot2c_f32_bf16 v4, v177, v17
v_dot2c_f32_bf16 v5, v177, v25
v_dot2c_f32_bf16 v6, v185, v17
v_dot2c_f32_bf16 v7, v185, v25
v_dot2c_f32_bf16 v4, v181, v21
v_dot2c_f32_bf16 v5, v181, v29
v_dot2c_f32_bf16 v6, v189, v21
v_dot2c_f32_bf16 v7, v189, v29
v_dot2c_f32_bf16 v4, v178, v18
v_dot2c_f32_bf16 v5, v178, v26
v_dot2c_f32_bf16 v6, v186, v18
v_dot2c_f32_bf16 v7, v186, v26
v_dot2c_f32_bf16 v4, v182, v22
v_dot2c_f32_bf16 v5, v182, v30
v_dot2c_f32_bf16 v6, v190, v22
v_dot2c_f32_bf16 v7, v190, v30
v_dot2c_f32_bf16 v4, v179, v19
v_dot2c_f32_bf16 v5, v179, v27
v_dot2c_f32_bf16 v6, v187, v19
v_dot2c_f32_bf16 v7, v187, v27
v_dot2c_f32_bf16 v4, v183, v23
v_dot2c_f32_bf16 v5, v183, v31
v_dot2c_f32_bf16 v6, v191, v23
v_dot2c_f32_bf16 v7, v191, v31
v_add_f32_dpp v4, v4, v4 quad_perm:[1,0,3,2] row_mask:0xf bank_mask:0xf
v_add_f32_dpp v5, v5, v5 quad_perm:[1,0,3,2] row_mask:0xf bank_mask:0xf
v_add_f32_dpp v6, v6, v6 quad_perm:[1,0,3,2] row_mask:0xf bank_mask:0xf
v_add_f32_dpp v7, v7, v7 quad_perm:[1,0,3,2] row_mask:0xf bank_mask:0xf
v_add_f32_dpp v4, v4, v4 quad_perm:[2,3,0,1] row_mask:0xf bank_mask:0xf
v_add_f32_dpp v5, v5, v5 quad_perm:[2,3,0,1] row_mask:0xf bank_mask:0xf
v_add_f32_dpp v6, v6, v6 quad_perm:[2,3,0,1] row_mask:0xf bank_mask:0xf
v_add_f32_dpp v7, v7, v7 quad_perm:[2,3,0,1] row_mask:0xf bank_mask:0xf
v_add_f32_dpp v4, v4, v4 row_half_mirror row_mask:0xf bank_mask:0xf
v_add_f32_dpp v5, v5, v5 row_half_mirror row_mask:0xf bank_mask:0xf
v_add_f32_dpp v6, v6, v6 row_half_mirror row_mask:0xf bank_mask:0xf
v_add_f32_dpp v7, v7, v7 row_half_mirror row_mask:0xf bank_mask:0xf
v_add_f32_dpp v4, v4, v4 row_mirror row_mask:0xf bank_mask:0xf
v_add_f32_dpp v5, v5, v5 row_mirror row_mask:0xf bank_mask:0xf
v_add_f32_dpp v6, v6, v6 row_mirror row_mask:0xf bank_mask:0xf
v_add_f32_dpp v7, v7, v7 row_mirror row_mask:0xf bank_mask:0xf
v_cvt_pk_bf16_f32 v64, v4, v6
v_cvt_pk_bf16_f32 v65, v5, v7
v_min_u32 v64, -2, v64
v_min_u32 v65, -2, v65
s_mov_b64 exec, s[80:81]
ds_write_b64 v236, v[64:65] offset:2240
s_mov_b64 exec, -1
s_waitcnt vmcnt(1)
v_mov_b32 v4, 0
v_mov_b32 v5, 0
v_mov_b32 v6, 0
v_mov_b32 v7, 0
v_dot2c_f32_bf16 v4, v192, v16
v_dot2c_f32_bf16 v5, v192, v24
v_dot2c_f32_bf16 v6, v200, v16
v_dot2c_f32_bf16 v7, v200, v24
v_dot2c_f32_bf16 v4, v196, v20
v_dot2c_f32_bf16 v5, v196, v28
v_dot2c_f32_bf16 v6, v204, v20
v_dot2c_f32_bf16 v7, v204, v28
v_dot2c_f32_bf16 v4, v193, v17
v_dot2c_f32_bf16 v5, v193, v25
v_dot2c_f32_bf16 v6, v201, v17
v_dot2c_f32_bf16 v7, v201, v25
v_dot2c_f32_bf16 v4, v197, v21
v_dot2c_f32_bf16 v5, v197, v29
v_dot2c_f32_bf16 v6, v205, v21
v_dot2c_f32_bf16 v7, v205, v29
v_dot2c_f32_bf16 v4, v194, v18
v_dot2c_f32_bf16 v5, v194, v26
v_dot2c_f32_bf16 v6, v202, v18
v_dot2c_f32_bf16 v7, v202, v26
v_dot2c_f32_bf16 v4, v198, v22
v_dot2c_f32_bf16 v5, v198, v30
v_dot2c_f32_bf16 v6, v206, v22
v_dot2c_f32_bf16 v7, v206, v30
v_dot2c_f32_bf16 v4, v195, v19
v_dot2c_f32_bf16 v5, v195, v27
v_dot2c_f32_bf16 v6, v203, v19
v_dot2c_f32_bf16 v7, v203, v27
v_dot2c_f32_bf16 v4, v199, v23
v_dot2c_f32_bf16 v5, v199, v31
v_dot2c_f32_bf16 v6, v207, v23
v_dot2c_f32_bf16 v7, v207, v31
v_add_f32_dpp v4, v4, v4 quad_perm:[1,0,3,2] row_mask:0xf bank_mask:0xf
v_add_f32_dpp v5, v5, v5 quad_perm:[1,0,3,2] row_mask:0xf bank_mask:0xf
v_add_f32_dpp v6, v6, v6 quad_perm:[1,0,3,2] row_mask:0xf bank_mask:0xf
v_add_f32_dpp v7, v7, v7 quad_perm:[1,0,3,2] row_mask:0xf bank_mask:0xf
v_add_f32_dpp v4, v4, v4 quad_perm:[2,3,0,1] row_mask:0xf bank_mask:0xf
v_add_f32_dpp v5, v5, v5 quad_perm:[2,3,0,1] row_mask:0xf bank_mask:0xf
v_add_f32_dpp v6, v6, v6 quad_perm:[2,3,0,1] row_mask:0xf bank_mask:0xf
v_add_f32_dpp v7, v7, v7 quad_perm:[2,3,0,1] row_mask:0xf bank_mask:0xf
v_add_f32_dpp v4, v4, v4 row_half_mirror row_mask:0xf bank_mask:0xf
v_add_f32_dpp v5, v5, v5 row_half_mirror row_mask:0xf bank_mask:0xf
v_add_f32_dpp v6, v6, v6 row_half_mirror row_mask:0xf bank_mask:0xf
v_add_f32_dpp v7, v7, v7 row_half_mirror row_mask:0xf bank_mask:0xf
v_add_f32_dpp v4, v4, v4 row_mirror row_mask:0xf bank_mask:0xf
v_add_f32_dpp v5, v5, v5 row_mirror row_mask:0xf bank_mask:0xf
v_add_f32_dpp v6, v6, v6 row_mirror row_mask:0xf bank_mask:0xf
v_add_f32_dpp v7, v7, v7 row_mirror row_mask:0xf bank_mask:0xf
v_cvt_pk_bf16_f32 v64, v4, v6
v_cvt_pk_bf16_f32 v65, v5, v7
v_min_u32 v64, -2, v64
v_min_u32 v65, -2, v65
s_mov_b64 exec, s[80:81]
ds_write_b64 v236, v[64:65] offset:2248
s_mov_b64 exec, -1
s_waitcnt vmcnt(0)
.Lsloop:
s_cmp_eq_u32 s64, 5
s_cbranch_scc1 .Lsdone
s_lshl_b32 s60, s68, 6
v_add_u32 v236, s60, v237
s_cmp_eq_u32 s64, 4
s_cbranch_scc1 .Li18
s_bitcmp1_b32 s64, 0
s_cbranch_scc1 .Lv17
s_waitcnt vmcnt(16)
v_mov_b32 v4, 0
v_mov_b32 v5, 0
v_mov_b32 v6, 0
v_mov_b32 v7, 0
v_dot2c_f32_bf16 v4, v80, v16
v_dot2c_f32_bf16 v5, v80, v24
v_dot2c_f32_bf16 v6, v88, v16
v_dot2c_f32_bf16 v7, v88, v24
v_dot2c_f32_bf16 v4, v84, v20
v_dot2c_f32_bf16 v5, v84, v28
v_dot2c_f32_bf16 v6, v92, v20
v_dot2c_f32_bf16 v7, v92, v28
v_dot2c_f32_bf16 v4, v81, v17
v_dot2c_f32_bf16 v5, v81, v25
v_dot2c_f32_bf16 v6, v89, v17
v_dot2c_f32_bf16 v7, v89, v25
v_dot2c_f32_bf16 v4, v85, v21
v_dot2c_f32_bf16 v5, v85, v29
v_dot2c_f32_bf16 v6, v93, v21
v_dot2c_f32_bf16 v7, v93, v29
v_dot2c_f32_bf16 v4, v82, v18
v_dot2c_f32_bf16 v5, v82, v26
v_dot2c_f32_bf16 v6, v90, v18
v_dot2c_f32_bf16 v7, v90, v26
v_dot2c_f32_bf16 v4, v86, v22
v_dot2c_f32_bf16 v5, v86, v30
v_dot2c_f32_bf16 v6, v94, v22
v_dot2c_f32_bf16 v7, v94, v30
v_dot2c_f32_bf16 v4, v83, v19
v_dot2c_f32_bf16 v5, v83, v27
v_dot2c_f32_bf16 v6, v91, v19
v_dot2c_f32_bf16 v7, v91, v27
v_dot2c_f32_bf16 v4, v87, v23
v_dot2c_f32_bf16 v5, v87, v31
v_dot2c_f32_bf16 v6, v95, v23
v_dot2c_f32_bf16 v7, v95, v31
s_branch .Li18
.Lv17:
s_mov_b32 s60, 0
s_cmp_eq_u32 s64, 3
s_cbranch_scc0 .Lsm11l
s_waitcnt vmcnt(20)
.Lsm11g:
v_mov_b32 v232, v248
v_mov_b32 v233, v249
v_mov_b32 v234, v250
v_mov_b32 v235, v251
s_branch .Lsm11c
.Lsm11l:
ds_read_b128 v[232:235], v236 offset:2240
s_waitcnt lgkmcnt(0)
.Lsm11c:
v_max3_u32 v64, v232, v233, v234
v_max_u32 v64, v64, v235
v_cmp_eq_u32 vcc, -1, v64
s_cbranch_vccz .Lsm11k
s_add_u32 s60, s60, 1
s_cmp_lt_u32 s60, 100000
s_cbranch_scc0 .Lsm11k
s_cmp_eq_u32 s64, 3
s_cbranch_scc0 .Lsm11l
buffer_load_dwordx4 v[248:251], v236, s[48:51], s83 offen sc1
s_waitcnt vmcnt(0)
s_branch .Lsm11g
.Lsm11k:
v_lshlrev_b32 v4, 16, v232
v_and_b32 v6, 0xffff0000, v232
v_lshlrev_b32 v5, 16, v233
v_and_b32 v7, 0xffff0000, v233
v_max_f32 v66, v4, v6
v_max_f32 v67, v5, v7
v_cmp_gt_f32 vcc, v66, v8
v_cmp_gt_f32 s[54:55], v67, v9
s_or_b64 s[54:55], vcc, s[54:55]
s_cbranch_scc0 .Lskip12
v_max_f32 v66, v66, v8
v_max_f32 v67, v67, v9
v_sub_f32 v68, v8, v66
v_sub_f32 v70, v9, v67
v_mul_f32 v68, s10, v68
v_mul_f32 v70, s10, v70
v_exp_f32 v68, v68
v_exp_f32 v70, v70
v_mov_b32 v8, v66
v_mul_f32 v12, s10, v66
v_mov_b32 v9, v67
v_mul_f32 v13, s10, v67
v_mul_f32 v10, v10, v68
v_pk_mul_f32 v[32:33], v[32:33], v[68:69] op_sel_hi:[1,0]
v_pk_mul_f32 v[34:35], v[34:35], v[68:69] op_sel_hi:[1,0]
v_pk_mul_f32 v[36:37], v[36:37], v[68:69] op_sel_hi:[1,0]
v_pk_mul_f32 v[38:39], v[38:39], v[68:69] op_sel_hi:[1,0]
v_pk_mul_f32 v[40:41], v[40:41], v[68:69] op_sel_hi:[1,0]
v_pk_mul_f32 v[42:43], v[42:43], v[68:69] op_sel_hi:[1,0]
v_pk_mul_f32 v[44:45], v[44:45], v[68:69] op_sel_hi:[1,0]
v_pk_mul_f32 v[46:47], v[46:47], v[68:69] op_sel_hi:[1,0]
v_mul_f32 v11, v11, v70
v_pk_mul_f32 v[48:49], v[48:49], v[70:71] op_sel_hi:[1,0]
v_pk_mul_f32 v[50:51], v[50:51], v[70:71] op_sel_hi:[1,0]
v_pk_mul_f32 v[52:53], v[52:53], v[70:71] op_sel_hi:[1,0]
v_pk_mul_f32 v[54:55], v[54:55], v[70:71] op_sel_hi:[1,0]
v_pk_mul_f32 v[56:57], v[56:57], v[70:71] op_sel_hi:[1,0]
v_pk_mul_f32 v[58:59], v[58:59], v[70:71] op_sel_hi:[1,0]
v_pk_mul_f32 v[60:61], v[60:61], v[70:71] op_sel_hi:[1,0]
v_pk_mul_f32 v[62:63], v[62:63], v[70:71] op_sel_hi:[1,0]
.Lskip12:
v_fma_f32 v4, v4, s10, -v12
v_fma_f32 v5, v5, s10, -v13
v_fma_f32 v6, v6, s10, -v12
v_fma_f32 v7, v7, s10, -v13
v_exp_f32 v4, v4
v_exp_f32 v5, v5
v_exp_f32 v6, v6
v_exp_f32 v7, v7
v_cvt_pk_bf16_f32 v14, v4, v6
v_add_f32 v10, v10, v4
v_cvt_pk_bf16_f32 v15, v5, v7
v_add_f32 v11, v11, v5
v_add_f32 v10, v10, v6
v_add_f32 v11, v11, v7
s_waitcnt vmcnt(16)
v_perm_b32 v72, v88, v80, s8
v_perm_b32 v73, v88, v80, s9
v_dot2c_f32_bf16 v32, v72, v14
v_dot2c_f32_bf16 v33, v73, v14
v_dot2c_f32_bf16 v48, v72, v15
v_dot2c_f32_bf16 v49, v73, v15
v_perm_b32 v74, v89, v81, s8
v_perm_b32 v75, v89, v81, s9
v_dot2c_f32_bf16 v34, v74, v14
v_dot2c_f32_bf16 v35, v75, v14
v_dot2c_f32_bf16 v50, v74, v15
v_dot2c_f32_bf16 v51, v75, v15
v_perm_b32 v72, v90, v82, s8
v_perm_b32 v73, v90, v82, s9
v_dot2c_f32_bf16 v36, v72, v14
v_dot2c_f32_bf16 v37, v73, v14
v_dot2c_f32_bf16 v52, v72, v15
v_dot2c_f32_bf16 v53, v73, v15
v_perm_b32 v74, v91, v83, s8
v_perm_b32 v75, v91, v83, s9
v_dot2c_f32_bf16 v38, v74, v14
v_dot2c_f32_bf16 v39, v75, v14
v_dot2c_f32_bf16 v54, v74, v15
v_dot2c_f32_bf16 v55, v75, v15
v_perm_b32 v72, v92, v84, s8
v_perm_b32 v73, v92, v84, s9
v_dot2c_f32_bf16 v40, v72, v14
v_dot2c_f32_bf16 v41, v73, v14
v_dot2c_f32_bf16 v56, v72, v15
v_dot2c_f32_bf16 v57, v73, v15
v_perm_b32 v74, v93, v85, s8
v_perm_b32 v75, v93, v85, s9
v_dot2c_f32_bf16 v42, v74, v14
v_dot2c_f32_bf16 v43, v75, v14
v_dot2c_f32_bf16 v58, v74, v15
v_dot2c_f32_bf16 v59, v75, v15
v_perm_b32 v72, v94, v86, s8
v_perm_b32 v73, v94, v86, s9
v_dot2c_f32_bf16 v44, v72, v14
v_dot2c_f32_bf16 v45, v73, v14
v_dot2c_f32_bf16 v60, v72, v15
v_dot2c_f32_bf16 v61, v73, v15
v_perm_b32 v74, v95, v87, s8
v_perm_b32 v75, v95, v87, s9
v_dot2c_f32_bf16 v46, v74, v14
v_dot2c_f32_bf16 v47, v75, v14
v_dot2c_f32_bf16 v62, v74, v15
v_dot2c_f32_bf16 v63, v75, v15
s_nop 2
.Li18:
s_mov_b32 s87, s85
s_mov_b32 s86, s57
s_mov_b32 s13, s56
s_cmp_lt_u32 s57, 2
s_cbranch_scc1 .Lkd13
s_waitcnt vmcnt(10)
v_readfirstlane_b32 s87, v78
s_mul_i32 s59, s87, 4096
s_lshr_b32 s59, s59, 16
s_mul_i32 s60, s59, 16
s_sub_u32 s61, s87, s60
s_add_u32 s61, s61, 48
s_lshl_b32 s59, s59, 19
s_add_u32 s59, s59, s12
s_add_u32 s60, s87, 4294967196
s_cmp_lt_u32 s87, 128
s_cselect_b32 s61, s61, s60
s_cselect_b32 s59, s59, s15
s_and_b32 s60, s61, 1
s_lshr_b32 s13, s61, 1
s_lshl_b32 s13, s13, 14
s_lshl_b32 s60, s60, 11
s_add_u32 s13, s13, s60
s_add_u32 s13, s13, s59
s_cmp_lt_u32 s87, s101
s_cbranch_scc1 .Lkd13
s_mov_b32 s86, 4
s_mov_b32 s13, 0x10000000
s_cmp_eq_u32 s57, 2
s_cselect_b32 s100, 1, 0
s_mov_b32 s84, 16
.Lkd13:
s_cmp_eq_u32 s100, 1
s_cselect_b32 s86, s86, 5
s_cselect_b32 s13, s13, 0x10000000
s_bitcmp1_b32 s86, 0
s_cselect_b64 s[40:41], s[20:21], s[18:19]
s_lshl_b32 s88, s87, 6
s_add_u32 s88, s88, s83
s_cmp_eq_u32 s86, 3
s_cselect_b32 s88, s88, 0x10000000
v_mov_b32 v78, 1
s_mov_b32 s57, 1
s_cmp_eq_u32 s100, 0
s_cbranch_scc1 .Lrd15
s_bitcmp1_b32 s84, 0
s_cbranch_scc1 .Lrg14a
v_mov_b32 v76, 1
v_mov_b32 v239, s84
s_mov_b64 exec, 1
ds_add_rtn_u32 v76, v239, v76 offset:1408
ds_read_b32 v77, v79 offset:1412
s_mov_b64 exec, -1
s_waitcnt lgkmcnt(0)
v_readfirstlane_b32 s85, v76
v_readfirstlane_b32 s59, v77
s_and_b32 s60, s85, 1
s_lshr_b32 s56, s85, 1
s_lshl_b32 s56, s56, 14
s_lshl_b32 s60, s60, 11
s_add_u32 s56, s56, s60
s_add_u32 s56, s56, s11
s_lshr_b32 s57, s84, 4
s_cmp_lt_u32 s85, s14
s_cbranch_scc1 .Lrd15
s_or_b32 s84, s84, 1
s_cmp_lg_u32 s59, 0
s_cbranch_scc1 .Lok16
s_mov_b32 s60, 0
.Lsp17:
s_sleep 2
ds_read_b32 v77, v79 offset:1412
s_waitcnt lgkmcnt(0)
v_readfirstlane_b32 s59, v77
s_add_u32 s60, s60, 1
s_cmp_lg_u32 s59, 0
s_cbranch_scc1 .Lok16
s_cmp_lt_u32 s60, 800000
s_cbranch_scc1 .Lsp17
.Lok16:
.Lrg14a:
s_lshr_b32 s57, s84, 4
s_lshl_b32 s58, s57, 7
s_add_u32 s58, s58, s7
s_add_u32 s57, s57, 2
s_mov_b64 exec, 1
buffer_atomic_add v78, v79, s[48:51], s58 offen sc0 sc1
s_mov_b64 exec, -1
s_branch .Lrd15e
.Lrd15:
s_mov_b64 exec, 1
buffer_load_dword v242, v79, s[48:51], s75 offen
s_mov_b64 exec, -1
.Lrd15e:
buffer_load_dwordx4 v[248:251], v237, s[48:51], s88 offen sc1
buffer_load_dwordx4 v[80:83], v1, s[40:43], s13 offen offset:0 nt
buffer_load_dwordx4 v[84:87], v1, s[40:43], s13 offen offset:256 nt
buffer_load_dwordx4 v[88:91], v1, s[40:43], s13 offen offset:512 nt
buffer_load_dwordx4 v[92:95], v1, s[40:43], s13 offen offset:768 nt
s_cmp_eq_u32 s64, 4
s_cbranch_scc1 .Li210
s_bitcmp1_b32 s64, 0
s_cbranch_scc0 .Lk29
v_lshlrev_b32 v4, 16, v234
v_and_b32 v6, 0xffff0000, v234
v_lshlrev_b32 v5, 16, v235
v_and_b32 v7, 0xffff0000, v235
v_max_f32 v66, v4, v6
v_max_f32 v67, v5, v7
v_cmp_gt_f32 vcc, v66, v8
v_cmp_gt_f32 s[54:55], v67, v9
s_or_b64 s[54:55], vcc, s[54:55]
s_cbranch_scc0 .Lskip18
v_max_f32 v66, v66, v8
v_max_f32 v67, v67, v9
v_sub_f32 v68, v8, v66
v_sub_f32 v70, v9, v67
v_mul_f32 v68, s10, v68
v_mul_f32 v70, s10, v70
v_exp_f32 v68, v68
v_exp_f32 v70, v70
v_mov_b32 v8, v66
v_mul_f32 v12, s10, v66
v_mov_b32 v9, v67
v_mul_f32 v13, s10, v67
v_mul_f32 v10, v10, v68
v_pk_mul_f32 v[32:33], v[32:33], v[68:69] op_sel_hi:[1,0]
v_pk_mul_f32 v[34:35], v[34:35], v[68:69] op_sel_hi:[1,0]
v_pk_mul_f32 v[36:37], v[36:37], v[68:69] op_sel_hi:[1,0]
v_pk_mul_f32 v[38:39], v[38:39], v[68:69] op_sel_hi:[1,0]
v_pk_mul_f32 v[40:41], v[40:41], v[68:69] op_sel_hi:[1,0]
v_pk_mul_f32 v[42:43], v[42:43], v[68:69] op_sel_hi:[1,0]
v_pk_mul_f32 v[44:45], v[44:45], v[68:69] op_sel_hi:[1,0]
v_pk_mul_f32 v[46:47], v[46:47], v[68:69] op_sel_hi:[1,0]
v_mul_f32 v11, v11, v70
v_pk_mul_f32 v[48:49], v[48:49], v[70:71] op_sel_hi:[1,0]
v_pk_mul_f32 v[50:51], v[50:51], v[70:71] op_sel_hi:[1,0]
v_pk_mul_f32 v[52:53], v[52:53], v[70:71] op_sel_hi:[1,0]
v_pk_mul_f32 v[54:55], v[54:55], v[70:71] op_sel_hi:[1,0]
v_pk_mul_f32 v[56:57], v[56:57], v[70:71] op_sel_hi:[1,0]
v_pk_mul_f32 v[58:59], v[58:59], v[70:71] op_sel_hi:[1,0]
v_pk_mul_f32 v[60:61], v[60:61], v[70:71] op_sel_hi:[1,0]
v_pk_mul_f32 v[62:63], v[62:63], v[70:71] op_sel_hi:[1,0]
.Lskip18:
v_fma_f32 v4, v4, s10, -v12
v_fma_f32 v5, v5, s10, -v13
v_fma_f32 v6, v6, s10, -v12
v_fma_f32 v7, v7, s10, -v13
v_exp_f32 v4, v4
v_exp_f32 v5, v5
v_exp_f32 v6, v6
v_exp_f32 v7, v7
v_cvt_pk_bf16_f32 v14, v4, v6
v_add_f32 v10, v10, v4
v_cvt_pk_bf16_f32 v15, v5, v7
v_add_f32 v11, v11, v5
v_add_f32 v10, v10, v6
v_add_f32 v11, v11, v7
s_waitcnt vmcnt(17)
v_perm_b32 v72, v104, v96, s8
v_perm_b32 v73, v104, v96, s9
v_dot2c_f32_bf16 v32, v72, v14
v_dot2c_f32_bf16 v33, v73, v14
v_dot2c_f32_bf16 v48, v72, v15
v_dot2c_f32_bf16 v49, v73, v15
v_perm_b32 v74, v105, v97, s8
v_perm_b32 v75, v105, v97, s9
v_dot2c_f32_bf16 v34, v74, v14
v_dot2c_f32_bf16 v35, v75, v14
v_dot2c_f32_bf16 v50, v74, v15
v_dot2c_f32_bf16 v51, v75, v15
v_perm_b32 v72, v106, v98, s8
v_perm_b32 v73, v106, v98, s9
v_dot2c_f32_bf16 v36, v72, v14
v_dot2c_f32_bf16 v37, v73, v14
v_dot2c_f32_bf16 v52, v72, v15
v_dot2c_f32_bf16 v53, v73, v15
v_perm_b32 v74, v107, v99, s8
v_perm_b32 v75, v107, v99, s9
v_dot2c_f32_bf16 v38, v74, v14
v_dot2c_f32_bf16 v39, v75, v14
v_dot2c_f32_bf16 v54, v74, v15
v_dot2c_f32_bf16 v55, v75, v15
v_perm_b32 v72, v108, v100, s8
v_perm_b32 v73, v108, v100, s9
v_dot2c_f32_bf16 v40, v72, v14
v_dot2c_f32_bf16 v41, v73, v14
v_dot2c_f32_bf16 v56, v72, v15
v_dot2c_f32_bf16 v57, v73, v15
v_perm_b32 v74, v109, v101, s8
v_perm_b32 v75, v109, v101, s9
v_dot2c_f32_bf16 v42, v74, v14
v_dot2c_f32_bf16 v43, v75, v14
v_dot2c_f32_bf16 v58, v74, v15
v_dot2c_f32_bf16 v59, v75, v15
v_perm_b32 v72, v110, v102, s8
v_perm_b32 v73, v110, v102, s9
v_dot2c_f32_bf16 v44, v72, v14
v_dot2c_f32_bf16 v45, v73, v14
v_dot2c_f32_bf16 v60, v72, v15
v_dot2c_f32_bf16 v61, v73, v15
v_perm_b32 v74, v111, v103, s8
v_perm_b32 v75, v111, v103, s9
v_dot2c_f32_bf16 v46, v74, v14
v_dot2c_f32_bf16 v47, v75, v14
v_dot2c_f32_bf16 v62, v74, v15
v_dot2c_f32_bf16 v63, v75, v15
s_nop 2
s_branch .Li210
.Lk29:
s_nop 2
v_add_f32_dpp v4, v4, v4 quad_perm:[1,0,3,2] row_mask:0xf bank_mask:0xf
v_add_f32_dpp v5, v5, v5 quad_perm:[1,0,3,2] row_mask:0xf bank_mask:0xf
v_add_f32_dpp v6, v6, v6 quad_perm:[1,0,3,2] row_mask:0xf bank_mask:0xf
v_add_f32_dpp v7, v7, v7 quad_perm:[1,0,3,2] row_mask:0xf bank_mask:0xf
v_add_f32_dpp v4, v4, v4 quad_perm:[2,3,0,1] row_mask:0xf bank_mask:0xf
v_add_f32_dpp v5, v5, v5 quad_perm:[2,3,0,1] row_mask:0xf bank_mask:0xf
v_add_f32_dpp v6, v6, v6 quad_perm:[2,3,0,1] row_mask:0xf bank_mask:0xf
v_add_f32_dpp v7, v7, v7 quad_perm:[2,3,0,1] row_mask:0xf bank_mask:0xf
v_add_f32_dpp v4, v4, v4 row_half_mirror row_mask:0xf bank_mask:0xf
v_add_f32_dpp v5, v5, v5 row_half_mirror row_mask:0xf bank_mask:0xf
v_add_f32_dpp v6, v6, v6 row_half_mirror row_mask:0xf bank_mask:0xf
v_add_f32_dpp v7, v7, v7 row_half_mirror row_mask:0xf bank_mask:0xf
v_add_f32_dpp v4, v4, v4 row_mirror row_mask:0xf bank_mask:0xf
v_add_f32_dpp v5, v5, v5 row_mirror row_mask:0xf bank_mask:0xf
v_add_f32_dpp v6, v6, v6 row_mirror row_mask:0xf bank_mask:0xf
v_add_f32_dpp v7, v7, v7 row_mirror row_mask:0xf bank_mask:0xf
v_cvt_pk_bf16_f32 v64, v4, v6
v_cvt_pk_bf16_f32 v65, v5, v7
v_min_u32 v232, -2, v64
v_min_u32 v233, -2, v65
s_waitcnt vmcnt(17)
v_mov_b32 v4, 0
v_mov_b32 v5, 0
v_mov_b32 v6, 0
v_mov_b32 v7, 0
v_dot2c_f32_bf16 v4, v96, v16
v_dot2c_f32_bf16 v5, v96, v24
v_dot2c_f32_bf16 v6, v104, v16
v_dot2c_f32_bf16 v7, v104, v24
v_dot2c_f32_bf16 v4, v100, v20
v_dot2c_f32_bf16 v5, v100, v28
v_dot2c_f32_bf16 v6, v108, v20
v_dot2c_f32_bf16 v7, v108, v28
v_dot2c_f32_bf16 v4, v97, v17
v_dot2c_f32_bf16 v5, v97, v25
v_dot2c_f32_bf16 v6, v105, v17
v_dot2c_f32_bf16 v7, v105, v25
v_dot2c_f32_bf16 v4, v101, v21
v_dot2c_f32_bf16 v5, v101, v29
v_dot2c_f32_bf16 v6, v109, v21
v_dot2c_f32_bf16 v7, v109, v29
v_dot2c_f32_bf16 v4, v98, v18
v_dot2c_f32_bf16 v5, v98, v26
v_dot2c_f32_bf16 v6, v106, v18
v_dot2c_f32_bf16 v7, v106, v26
v_dot2c_f32_bf16 v4, v102, v22
v_dot2c_f32_bf16 v5, v102, v30
v_dot2c_f32_bf16 v6, v110, v22
v_dot2c_f32_bf16 v7, v110, v30
v_dot2c_f32_bf16 v4, v99, v19
v_dot2c_f32_bf16 v5, v99, v27
v_dot2c_f32_bf16 v6, v107, v19
v_dot2c_f32_bf16 v7, v107, v27
v_dot2c_f32_bf16 v4, v103, v23
v_dot2c_f32_bf16 v5, v103, v31
v_dot2c_f32_bf16 v6, v111, v23
v_dot2c_f32_bf16 v7, v111, v31
v_add_f32_dpp v4, v4, v4 quad_perm:[1,0,3,2] row_mask:0xf bank_mask:0xf
v_add_f32_dpp v5, v5, v5 quad_perm:[1,0,3,2] row_mask:0xf bank_mask:0xf
v_add_f32_dpp v6, v6, v6 quad_perm:[1,0,3,2] row_mask:0xf bank_mask:0xf
v_add_f32_dpp v7, v7, v7 quad_perm:[1,0,3,2] row_mask:0xf bank_mask:0xf
v_add_f32_dpp v4, v4, v4 quad_perm:[2,3,0,1] row_mask:0xf bank_mask:0xf
v_add_f32_dpp v5, v5, v5 quad_perm:[2,3,0,1] row_mask:0xf bank_mask:0xf
v_add_f32_dpp v6, v6, v6 quad_perm:[2,3,0,1] row_mask:0xf bank_mask:0xf
v_add_f32_dpp v7, v7, v7 quad_perm:[2,3,0,1] row_mask:0xf bank_mask:0xf
v_add_f32_dpp v4, v4, v4 row_half_mirror row_mask:0xf bank_mask:0xf
v_add_f32_dpp v5, v5, v5 row_half_mirror row_mask:0xf bank_mask:0xf
v_add_f32_dpp v6, v6, v6 row_half_mirror row_mask:0xf bank_mask:0xf
v_add_f32_dpp v7, v7, v7 row_half_mirror row_mask:0xf bank_mask:0xf
v_add_f32_dpp v4, v4, v4 row_mirror row_mask:0xf bank_mask:0xf
v_add_f32_dpp v5, v5, v5 row_mirror row_mask:0xf bank_mask:0xf
v_add_f32_dpp v6, v6, v6 row_mirror row_mask:0xf bank_mask:0xf
v_add_f32_dpp v7, v7, v7 row_mirror row_mask:0xf bank_mask:0xf
v_cvt_pk_bf16_f32 v64, v4, v6
v_cvt_pk_bf16_f32 v65, v5, v7
v_min_u32 v234, -2, v64
v_min_u32 v235, -2, v65
s_mov_b64 exec, s[80:81]
s_cmp_eq_u32 s64, 2
s_cbranch_scc1 .Lk29g
ds_write_b128 v236, v[232:235] offset:2240
s_mov_b64 exec, -1
s_branch .Li210
.Lk29g:
buffer_store_dwordx4 v[232:235], v236, s[48:51], s83 offen sc1
s_mov_b64 exec, -1
s_branch .Li210x
.Li210:
s_mov_b64 exec, 1
buffer_load_dword v242, v79, s[48:51], s75 offen
s_mov_b64 exec, -1
.Li210x:
s_mov_b64 s[44:45], s[40:41]
s_mov_b32 s64, s86
s_mov_b32 s68, s87
buffer_load_dwordx4 v[96:99], v1, s[44:47], s13 offen offset:1024 nt
buffer_load_dwordx4 v[100:103], v1, s[44:47], s13 offen offset:1280 nt
buffer_load_dwordx4 v[104:107], v1, s[44:47], s13 offen offset:1536 nt
buffer_load_dwordx4 v[108:111], v1, s[44:47], s13 offen offset:1792 nt
s_cmp_eq_u32 s65, 5
s_cbranch_scc1 .Lsdone
s_lshl_b32 s60, s69, 6
v_add_u32 v236, s60, v237
s_cmp_eq_u32 s65, 4
s_cbranch_scc1 .Li120
s_bitcmp1_b32 s65, 0
s_cbranch_scc1 .Lv119
s_waitcnt vmcnt(16)
v_mov_b32 v4, 0
v_mov_b32 v5, 0
v_mov_b32 v6, 0
v_mov_b32 v7, 0
v_dot2c_f32_bf16 v4, v112, v16
v_dot2c_f32_bf16 v5, v112, v24
v_dot2c_f32_bf16 v6, v120, v16
v_dot2c_f32_bf16 v7, v120, v24
v_dot2c_f32_bf16 v4, v116, v20
v_dot2c_f32_bf16 v5, v116, v28
v_dot2c_f32_bf16 v6, v124, v20
v_dot2c_f32_bf16 v7, v124, v28
v_dot2c_f32_bf16 v4, v113, v17
v_dot2c_f32_bf16 v5, v113, v25
v_dot2c_f32_bf16 v6, v121, v17
v_dot2c_f32_bf16 v7, v121, v25
v_dot2c_f32_bf16 v4, v117, v21
v_dot2c_f32_bf16 v5, v117, v29
v_dot2c_f32_bf16 v6, v125, v21
v_dot2c_f32_bf16 v7, v125, v29
v_dot2c_f32_bf16 v4, v114, v18
v_dot2c_f32_bf16 v5, v114, v26
v_dot2c_f32_bf16 v6, v122, v18
v_dot2c_f32_bf16 v7, v122, v26
v_dot2c_f32_bf16 v4, v118, v22
v_dot2c_f32_bf16 v5, v118, v30
v_dot2c_f32_bf16 v6, v126, v22
v_dot2c_f32_bf16 v7, v126, v30
v_dot2c_f32_bf16 v4, v115, v19
v_dot2c_f32_bf16 v5, v115, v27
v_dot2c_f32_bf16 v6, v123, v19
v_dot2c_f32_bf16 v7, v123, v27
v_dot2c_f32_bf16 v4, v119, v23
v_dot2c_f32_bf16 v5, v119, v31
v_dot2c_f32_bf16 v6, v127, v23
v_dot2c_f32_bf16 v7, v127, v31
s_branch .Li120
.Lv119:
s_mov_b32 s60, 0
s_cmp_eq_u32 s65, 3
s_cbranch_scc0 .Lsm23l
s_waitcnt vmcnt(20)
.Lsm23g:
v_mov_b32 v232, v252
v_mov_b32 v233, v253
v_mov_b32 v234, v254
v_mov_b32 v235, v255
s_branch .Lsm23c
.Lsm23l:
ds_read_b128 v[232:235], v236 offset:2240
s_waitcnt lgkmcnt(0)
.Lsm23c:
v_max3_u32 v64, v232, v233, v234
v_max_u32 v64, v64, v235
v_cmp_eq_u32 vcc, -1, v64
s_cbranch_vccz .Lsm23k
s_add_u32 s60, s60, 1
s_cmp_lt_u32 s60, 100000
s_cbranch_scc0 .Lsm23k
s_cmp_eq_u32 s65, 3
s_cbranch_scc0 .Lsm23l
buffer_load_dwordx4 v[252:255], v236, s[48:51], s83 offen sc1
s_waitcnt vmcnt(0)
s_branch .Lsm23g
.Lsm23k:
v_lshlrev_b32 v4, 16, v232
v_and_b32 v6, 0xffff0000, v232
v_lshlrev_b32 v5, 16, v233
v_and_b32 v7, 0xffff0000, v233
v_max_f32 v66, v4, v6
v_max_f32 v67, v5, v7
v_cmp_gt_f32 vcc, v66, v8
v_cmp_gt_f32 s[54:55], v67, v9
s_or_b64 s[54:55], vcc, s[54:55]
s_cbranch_scc0 .Lskip24
v_max_f32 v66, v66, v8
v_max_f32 v67, v67, v9
v_sub_f32 v68, v8, v66
v_sub_f32 v70, v9, v67
v_mul_f32 v68, s10, v68
v_mul_f32 v70, s10, v70
v_exp_f32 v68, v68
v_exp_f32 v70, v70
v_mov_b32 v8, v66
v_mul_f32 v12, s10, v66
v_mov_b32 v9, v67
v_mul_f32 v13, s10, v67
v_mul_f32 v10, v10, v68
v_pk_mul_f32 v[32:33], v[32:33], v[68:69] op_sel_hi:[1,0]
v_pk_mul_f32 v[34:35], v[34:35], v[68:69] op_sel_hi:[1,0]
v_pk_mul_f32 v[36:37], v[36:37], v[68:69] op_sel_hi:[1,0]
v_pk_mul_f32 v[38:39], v[38:39], v[68:69] op_sel_hi:[1,0]
v_pk_mul_f32 v[40:41], v[40:41], v[68:69] op_sel_hi:[1,0]
v_pk_mul_f32 v[42:43], v[42:43], v[68:69] op_sel_hi:[1,0]
v_pk_mul_f32 v[44:45], v[44:45], v[68:69] op_sel_hi:[1,0]
v_pk_mul_f32 v[46:47], v[46:47], v[68:69] op_sel_hi:[1,0]
v_mul_f32 v11, v11, v70
v_pk_mul_f32 v[48:49], v[48:49], v[70:71] op_sel_hi:[1,0]
v_pk_mul_f32 v[50:51], v[50:51], v[70:71] op_sel_hi:[1,0]
v_pk_mul_f32 v[52:53], v[52:53], v[70:71] op_sel_hi:[1,0]
v_pk_mul_f32 v[54:55], v[54:55], v[70:71] op_sel_hi:[1,0]
v_pk_mul_f32 v[56:57], v[56:57], v[70:71] op_sel_hi:[1,0]
v_pk_mul_f32 v[58:59], v[58:59], v[70:71] op_sel_hi:[1,0]
v_pk_mul_f32 v[60:61], v[60:61], v[70:71] op_sel_hi:[1,0]
v_pk_mul_f32 v[62:63], v[62:63], v[70:71] op_sel_hi:[1,0]
.Lskip24:
v_fma_f32 v4, v4, s10, -v12
v_fma_f32 v5, v5, s10, -v13
v_fma_f32 v6, v6, s10, -v12
v_fma_f32 v7, v7, s10, -v13
v_exp_f32 v4, v4
v_exp_f32 v5, v5
v_exp_f32 v6, v6
v_exp_f32 v7, v7
v_cvt_pk_bf16_f32 v14, v4, v6
v_add_f32 v10, v10, v4
v_cvt_pk_bf16_f32 v15, v5, v7
v_add_f32 v11, v11, v5
v_add_f32 v10, v10, v6
v_add_f32 v11, v11, v7
s_waitcnt vmcnt(16)
v_perm_b32 v72, v120, v112, s8
v_perm_b32 v73, v120, v112, s9
v_dot2c_f32_bf16 v32, v72, v14
v_dot2c_f32_bf16 v33, v73, v14
v_dot2c_f32_bf16 v48, v72, v15
v_dot2c_f32_bf16 v49, v73, v15
v_perm_b32 v74, v121, v113, s8
v_perm_b32 v75, v121, v113, s9
v_dot2c_f32_bf16 v34, v74, v14
v_dot2c_f32_bf16 v35, v75, v14
v_dot2c_f32_bf16 v50, v74, v15
v_dot2c_f32_bf16 v51, v75, v15
v_perm_b32 v72, v122, v114, s8
v_perm_b32 v73, v122, v114, s9
v_dot2c_f32_bf16 v36, v72, v14
v_dot2c_f32_bf16 v37, v73, v14
v_dot2c_f32_bf16 v52, v72, v15
v_dot2c_f32_bf16 v53, v73, v15
v_perm_b32 v74, v123, v115, s8
v_perm_b32 v75, v123, v115, s9
v_dot2c_f32_bf16 v38, v74, v14
v_dot2c_f32_bf16 v39, v75, v14
v_dot2c_f32_bf16 v54, v74, v15
v_dot2c_f32_bf16 v55, v75, v15
v_perm_b32 v72, v124, v116, s8
v_perm_b32 v73, v124, v116, s9
v_dot2c_f32_bf16 v40, v72, v14
v_dot2c_f32_bf16 v41, v73, v14
v_dot2c_f32_bf16 v56, v72, v15
v_dot2c_f32_bf16 v57, v73, v15
v_perm_b32 v74, v125, v117, s8
v_perm_b32 v75, v125, v117, s9
v_dot2c_f32_bf16 v42, v74, v14
v_dot2c_f32_bf16 v43, v75, v14
v_dot2c_f32_bf16 v58, v74, v15
v_dot2c_f32_bf16 v59, v75, v15
v_perm_b32 v72, v126, v118, s8
v_perm_b32 v73, v126, v118, s9
v_dot2c_f32_bf16 v44, v72, v14
v_dot2c_f32_bf16 v45, v73, v14
v_dot2c_f32_bf16 v60, v72, v15
v_dot2c_f32_bf16 v61, v73, v15
v_perm_b32 v74, v127, v119, s8
v_perm_b32 v75, v127, v119, s9
v_dot2c_f32_bf16 v46, v74, v14
v_dot2c_f32_bf16 v47, v75, v14
v_dot2c_f32_bf16 v62, v74, v15
v_dot2c_f32_bf16 v63, v75, v15
s_nop 2
.Li120:
s_mov_b32 s87, s85
s_mov_b32 s86, s57
s_mov_b32 s13, s56
s_cmp_lt_u32 s57, 2
s_cbranch_scc1 .Lkd25
s_waitcnt vmcnt(10)
v_readfirstlane_b32 s87, v78
s_mul_i32 s59, s87, 4096
s_lshr_b32 s59, s59, 16
s_mul_i32 s60, s59, 16
s_sub_u32 s61, s87, s60
s_add_u32 s61, s61, 48
s_lshl_b32 s59, s59, 19
s_add_u32 s59, s59, s12
s_add_u32 s60, s87, 4294967196
s_cmp_lt_u32 s87, 128
s_cselect_b32 s61, s61, s60
s_cselect_b32 s59, s59, s15
s_and_b32 s60, s61, 1
s_lshr_b32 s13, s61, 1
s_lshl_b32 s13, s13, 14
s_lshl_b32 s60, s60, 11
s_add_u32 s13, s13, s60
s_add_u32 s13, s13, s59
s_cmp_lt_u32 s87, s101
s_cbranch_scc1 .Lkd25
s_mov_b32 s86, 4
s_mov_b32 s13, 0x10000000
s_cmp_eq_u32 s57, 2
s_cselect_b32 s100, 1, 0
s_mov_b32 s84, 16
.Lkd25:
s_cmp_eq_u32 s100, 1
s_cselect_b32 s86, s86, 5
s_cselect_b32 s13, s13, 0x10000000
s_bitcmp1_b32 s86, 0
s_cselect_b64 s[40:41], s[20:21], s[18:19]
s_lshl_b32 s88, s87, 6
s_add_u32 s88, s88, s83
s_cmp_eq_u32 s86, 3
s_cselect_b32 s88, s88, 0x10000000
v_mov_b32 v78, 1
s_mov_b32 s57, 1
s_cmp_eq_u32 s100, 0
s_cbranch_scc1 .Lrd27
s_bitcmp1_b32 s84, 0
s_cbranch_scc1 .Lrg26a
v_mov_b32 v76, 1
v_mov_b32 v239, s84
s_mov_b64 exec, 1
ds_add_rtn_u32 v76, v239, v76 offset:1408
ds_read_b32 v77, v79 offset:1412
s_mov_b64 exec, -1
s_waitcnt lgkmcnt(0)
v_readfirstlane_b32 s85, v76
v_readfirstlane_b32 s59, v77
s_and_b32 s60, s85, 1
s_lshr_b32 s56, s85, 1
s_lshl_b32 s56, s56, 14
s_lshl_b32 s60, s60, 11
s_add_u32 s56, s56, s60
s_add_u32 s56, s56, s11
s_lshr_b32 s57, s84, 4
s_cmp_lt_u32 s85, s14
s_cbranch_scc1 .Lrd27
s_or_b32 s84, s84, 1
s_cmp_lg_u32 s59, 0
s_cbranch_scc1 .Lok28
s_mov_b32 s60, 0
.Lsp29:
s_sleep 2
ds_read_b32 v77, v79 offset:1412
s_waitcnt lgkmcnt(0)
v_readfirstlane_b32 s59, v77
s_add_u32 s60, s60, 1
s_cmp_lg_u32 s59, 0
s_cbranch_scc1 .Lok28
s_cmp_lt_u32 s60, 800000
s_cbranch_scc1 .Lsp29
.Lok28:
.Lrg26a:
s_lshr_b32 s57, s84, 4
s_lshl_b32 s58, s57, 7
s_add_u32 s58, s58, s7
s_add_u32 s57, s57, 2
s_mov_b64 exec, 1
buffer_atomic_add v78, v79, s[48:51], s58 offen sc0 sc1
s_mov_b64 exec, -1
s_branch .Lrd27e
.Lrd27:
s_mov_b64 exec, 1
buffer_load_dword v242, v79, s[48:51], s75 offen
s_mov_b64 exec, -1
.Lrd27e:
buffer_load_dwordx4 v[252:255], v237, s[48:51], s88 offen sc1
buffer_load_dwordx4 v[112:115], v1, s[40:43], s13 offen offset:0 nt
buffer_load_dwordx4 v[116:119], v1, s[40:43], s13 offen offset:256 nt
buffer_load_dwordx4 v[120:123], v1, s[40:43], s13 offen offset:512 nt
buffer_load_dwordx4 v[124:127], v1, s[40:43], s13 offen offset:768 nt
s_cmp_eq_u32 s65, 4
s_cbranch_scc1 .Li222
s_bitcmp1_b32 s65, 0
s_cbranch_scc0 .Lk221
v_lshlrev_b32 v4, 16, v234
v_and_b32 v6, 0xffff0000, v234
v_lshlrev_b32 v5, 16, v235
v_and_b32 v7, 0xffff0000, v235
v_max_f32 v66, v4, v6
v_max_f32 v67, v5, v7
v_cmp_gt_f32 vcc, v66, v8
v_cmp_gt_f32 s[54:55], v67, v9
s_or_b64 s[54:55], vcc, s[54:55]
s_cbranch_scc0 .Lskip30
v_max_f32 v66, v66, v8
v_max_f32 v67, v67, v9
v_sub_f32 v68, v8, v66
v_sub_f32 v70, v9, v67
v_mul_f32 v68, s10, v68
v_mul_f32 v70, s10, v70
v_exp_f32 v68, v68
v_exp_f32 v70, v70
v_mov_b32 v8, v66
v_mul_f32 v12, s10, v66
v_mov_b32 v9, v67
v_mul_f32 v13, s10, v67
v_mul_f32 v10, v10, v68
v_pk_mul_f32 v[32:33], v[32:33], v[68:69] op_sel_hi:[1,0]
v_pk_mul_f32 v[34:35], v[34:35], v[68:69] op_sel_hi:[1,0]
v_pk_mul_f32 v[36:37], v[36:37], v[68:69] op_sel_hi:[1,0]
v_pk_mul_f32 v[38:39], v[38:39], v[68:69] op_sel_hi:[1,0]
v_pk_mul_f32 v[40:41], v[40:41], v[68:69] op_sel_hi:[1,0]
v_pk_mul_f32 v[42:43], v[42:43], v[68:69] op_sel_hi:[1,0]
v_pk_mul_f32 v[44:45], v[44:45], v[68:69] op_sel_hi:[1,0]
v_pk_mul_f32 v[46:47], v[46:47], v[68:69] op_sel_hi:[1,0]
v_mul_f32 v11, v11, v70
v_pk_mul_f32 v[48:49], v[48:49], v[70:71] op_sel_hi:[1,0]
v_pk_mul_f32 v[50:51], v[50:51], v[70:71] op_sel_hi:[1,0]
v_pk_mul_f32 v[52:53], v[52:53], v[70:71] op_sel_hi:[1,0]
v_pk_mul_f32 v[54:55], v[54:55], v[70:71] op_sel_hi:[1,0]
v_pk_mul_f32 v[56:57], v[56:57], v[70:71] op_sel_hi:[1,0]
v_pk_mul_f32 v[58:59], v[58:59], v[70:71] op_sel_hi:[1,0]
v_pk_mul_f32 v[60:61], v[60:61], v[70:71] op_sel_hi:[1,0]
v_pk_mul_f32 v[62:63], v[62:63], v[70:71] op_sel_hi:[1,0]
.Lskip30:
v_fma_f32 v4, v4, s10, -v12
v_fma_f32 v5, v5, s10, -v13
v_fma_f32 v6, v6, s10, -v12
v_fma_f32 v7, v7, s10, -v13
v_exp_f32 v4, v4
v_exp_f32 v5, v5
v_exp_f32 v6, v6
v_exp_f32 v7, v7
v_cvt_pk_bf16_f32 v14, v4, v6
v_add_f32 v10, v10, v4
v_cvt_pk_bf16_f32 v15, v5, v7
v_add_f32 v11, v11, v5
v_add_f32 v10, v10, v6
v_add_f32 v11, v11, v7
s_waitcnt vmcnt(17)
v_perm_b32 v72, v136, v128, s8
v_perm_b32 v73, v136, v128, s9
v_dot2c_f32_bf16 v32, v72, v14
v_dot2c_f32_bf16 v33, v73, v14
v_dot2c_f32_bf16 v48, v72, v15
v_dot2c_f32_bf16 v49, v73, v15
v_perm_b32 v74, v137, v129, s8
v_perm_b32 v75, v137, v129, s9
v_dot2c_f32_bf16 v34, v74, v14
v_dot2c_f32_bf16 v35, v75, v14
v_dot2c_f32_bf16 v50, v74, v15
v_dot2c_f32_bf16 v51, v75, v15
v_perm_b32 v72, v138, v130, s8
v_perm_b32 v73, v138, v130, s9
v_dot2c_f32_bf16 v36, v72, v14
v_dot2c_f32_bf16 v37, v73, v14
v_dot2c_f32_bf16 v52, v72, v15
v_dot2c_f32_bf16 v53, v73, v15
v_perm_b32 v74, v139, v131, s8
v_perm_b32 v75, v139, v131, s9
v_dot2c_f32_bf16 v38, v74, v14
v_dot2c_f32_bf16 v39, v75, v14
v_dot2c_f32_bf16 v54, v74, v15
v_dot2c_f32_bf16 v55, v75, v15
v_perm_b32 v72, v140, v132, s8
v_perm_b32 v73, v140, v132, s9
v_dot2c_f32_bf16 v40, v72, v14
v_dot2c_f32_bf16 v41, v73, v14
v_dot2c_f32_bf16 v56, v72, v15
v_dot2c_f32_bf16 v57, v73, v15
v_perm_b32 v74, v141, v133, s8
v_perm_b32 v75, v141, v133, s9
v_dot2c_f32_bf16 v42, v74, v14
v_dot2c_f32_bf16 v43, v75, v14
v_dot2c_f32_bf16 v58, v74, v15
v_dot2c_f32_bf16 v59, v75, v15
v_perm_b32 v72, v142, v134, s8
v_perm_b32 v73, v142, v134, s9
v_dot2c_f32_bf16 v44, v72, v14
v_dot2c_f32_bf16 v45, v73, v14
v_dot2c_f32_bf16 v60, v72, v15
v_dot2c_f32_bf16 v61, v73, v15
v_perm_b32 v74, v143, v135, s8
v_perm_b32 v75, v143, v135, s9
v_dot2c_f32_bf16 v46, v74, v14
v_dot2c_f32_bf16 v47, v75, v14
v_dot2c_f32_bf16 v62, v74, v15
v_dot2c_f32_bf16 v63, v75, v15
s_nop 2
s_branch .Li222
.Lk221:
s_nop 2
v_add_f32_dpp v4, v4, v4 quad_perm:[1,0,3,2] row_mask:0xf bank_mask:0xf
v_add_f32_dpp v5, v5, v5 quad_perm:[1,0,3,2] row_mask:0xf bank_mask:0xf
v_add_f32_dpp v6, v6, v6 quad_perm:[1,0,3,2] row_mask:0xf bank_mask:0xf
v_add_f32_dpp v7, v7, v7 quad_perm:[1,0,3,2] row_mask:0xf bank_mask:0xf
v_add_f32_dpp v4, v4, v4 quad_perm:[2,3,0,1] row_mask:0xf bank_mask:0xf
v_add_f32_dpp v5, v5, v5 quad_perm:[2,3,0,1] row_mask:0xf bank_mask:0xf
v_add_f32_dpp v6, v6, v6 quad_perm:[2,3,0,1] row_mask:0xf bank_mask:0xf
v_add_f32_dpp v7, v7, v7 quad_perm:[2,3,0,1] row_mask:0xf bank_mask:0xf
v_add_f32_dpp v4, v4, v4 row_half_mirror row_mask:0xf bank_mask:0xf
v_add_f32_dpp v5, v5, v5 row_half_mirror row_mask:0xf bank_mask:0xf
v_add_f32_dpp v6, v6, v6 row_half_mirror row_mask:0xf bank_mask:0xf
v_add_f32_dpp v7, v7, v7 row_half_mirror row_mask:0xf bank_mask:0xf
v_add_f32_dpp v4, v4, v4 row_mirror row_mask:0xf bank_mask:0xf
v_add_f32_dpp v5, v5, v5 row_mirror row_mask:0xf bank_mask:0xf
v_add_f32_dpp v6, v6, v6 row_mirror row_mask:0xf bank_mask:0xf
v_add_f32_dpp v7, v7, v7 row_mirror row_mask:0xf bank_mask:0xf
v_cvt_pk_bf16_f32 v64, v4, v6
v_cvt_pk_bf16_f32 v65, v5, v7
v_min_u32 v232, -2, v64
v_min_u32 v233, -2, v65
s_waitcnt vmcnt(17)
v_mov_b32 v4, 0
v_mov_b32 v5, 0
v_mov_b32 v6, 0
v_mov_b32 v7, 0
v_dot2c_f32_bf16 v4, v128, v16
v_dot2c_f32_bf16 v5, v128, v24
v_dot2c_f32_bf16 v6, v136, v16
v_dot2c_f32_bf16 v7, v136, v24
v_dot2c_f32_bf16 v4, v132, v20
v_dot2c_f32_bf16 v5, v132, v28
v_dot2c_f32_bf16 v6, v140, v20
v_dot2c_f32_bf16 v7, v140, v28
v_dot2c_f32_bf16 v4, v129, v17
v_dot2c_f32_bf16 v5, v129, v25
v_dot2c_f32_bf16 v6, v137, v17
v_dot2c_f32_bf16 v7, v137, v25
v_dot2c_f32_bf16 v4, v133, v21
v_dot2c_f32_bf16 v5, v133, v29
v_dot2c_f32_bf16 v6, v141, v21
v_dot2c_f32_bf16 v7, v141, v29
v_dot2c_f32_bf16 v4, v130, v18
v_dot2c_f32_bf16 v5, v130, v26
v_dot2c_f32_bf16 v6, v138, v18
v_dot2c_f32_bf16 v7, v138, v26
v_dot2c_f32_bf16 v4, v134, v22
v_dot2c_f32_bf16 v5, v134, v30
v_dot2c_f32_bf16 v6, v142, v22
v_dot2c_f32_bf16 v7, v142, v30
v_dot2c_f32_bf16 v4, v131, v19
v_dot2c_f32_bf16 v5, v131, v27
v_dot2c_f32_bf16 v6, v139, v19
v_dot2c_f32_bf16 v7, v139, v27
v_dot2c_f32_bf16 v4, v135, v23
v_dot2c_f32_bf16 v5, v135, v31
v_dot2c_f32_bf16 v6, v143, v23
v_dot2c_f32_bf16 v7, v143, v31
v_add_f32_dpp v4, v4, v4 quad_perm:[1,0,3,2] row_mask:0xf bank_mask:0xf
v_add_f32_dpp v5, v5, v5 quad_perm:[1,0,3,2] row_mask:0xf bank_mask:0xf
v_add_f32_dpp v6, v6, v6 quad_perm:[1,0,3,2] row_mask:0xf bank_mask:0xf
v_add_f32_dpp v7, v7, v7 quad_perm:[1,0,3,2] row_mask:0xf bank_mask:0xf
v_add_f32_dpp v4, v4, v4 quad_perm:[2,3,0,1] row_mask:0xf bank_mask:0xf
v_add_f32_dpp v5, v5, v5 quad_perm:[2,3,0,1] row_mask:0xf bank_mask:0xf
v_add_f32_dpp v6, v6, v6 quad_perm:[2,3,0,1] row_mask:0xf bank_mask:0xf
v_add_f32_dpp v7, v7, v7 quad_perm:[2,3,0,1] row_mask:0xf bank_mask:0xf
v_add_f32_dpp v4, v4, v4 row_half_mirror row_mask:0xf bank_mask:0xf
v_add_f32_dpp v5, v5, v5 row_half_mirror row_mask:0xf bank_mask:0xf
v_add_f32_dpp v6, v6, v6 row_half_mirror row_mask:0xf bank_mask:0xf
v_add_f32_dpp v7, v7, v7 row_half_mirror row_mask:0xf bank_mask:0xf
v_add_f32_dpp v4, v4, v4 row_mirror row_mask:0xf bank_mask:0xf
v_add_f32_dpp v5, v5, v5 row_mirror row_mask:0xf bank_mask:0xf
v_add_f32_dpp v6, v6, v6 row_mirror row_mask:0xf bank_mask:0xf
v_add_f32_dpp v7, v7, v7 row_mirror row_mask:0xf bank_mask:0xf
v_cvt_pk_bf16_f32 v64, v4, v6
v_cvt_pk_bf16_f32 v65, v5, v7
v_min_u32 v234, -2, v64
v_min_u32 v235, -2, v65
s_mov_b64 exec, s[80:81]
s_cmp_eq_u32 s65, 2
s_cbranch_scc1 .Lk221g
ds_write_b128 v236, v[232:235] offset:2240
s_mov_b64 exec, -1
s_branch .Li222
.Lk221g:
buffer_store_dwordx4 v[232:235], v236, s[48:51], s83 offen sc1
s_mov_b64 exec, -1
s_branch .Li222x
.Li222:
s_mov_b64 exec, 1
buffer_load_dword v242, v79, s[48:51], s75 offen
s_mov_b64 exec, -1
.Li222x:
s_mov_b64 s[44:45], s[40:41]
s_mov_b32 s65, s86
s_mov_b32 s69, s87
buffer_load_dwordx4 v[128:131], v1, s[44:47], s13 offen offset:1024 nt
buffer_load_dwordx4 v[132:135], v1, s[44:47], s13 offen offset:1280 nt
buffer_load_dwordx4 v[136:139], v1, s[44:47], s13 offen offset:1536 nt
buffer_load_dwordx4 v[140:143], v1, s[44:47], s13 offen offset:1792 nt
s_branch .Lsloop
.Lsdone:
s_cmp_lt_u32 s6, 4
s_cbranch_scc0 .Lbar2
ds_write_b128 v240, v[32:35] offset:10432
ds_write_b128 v240, v[36:39] offset:11456
ds_write_b128 v240, v[40:43] offset:12480
ds_write_b128 v240, v[44:47] offset:13504
ds_write_b128 v240, v[48:51] offset:14528
ds_write_b128 v240, v[52:55] offset:15552
ds_write_b128 v240, v[56:59] offset:16576
ds_write_b128 v240, v[60:63] offset:17600
ds_write_b128 v241, v[8:11] offset:1472
s_waitcnt lgkmcnt(0)
.Lbar2:
s_barrier
s_cmp_lt_u32 s6, 3
s_cbranch_scc1 .Lsend
ds_read2_b32 v[16:17], v247 offset0:0 offset1:2
ds_read_b128 v[176:179], v245 offset:10432
ds_read_b128 v[180:183], v245 offset:10688
ds_read_b128 v[184:187], v245 offset:18624
ds_read_b128 v[188:191], v245 offset:18880
ds_read_b128 v[192:195], v245 offset:26816
ds_read_b128 v[196:199], v245 offset:27072
ds_read_b128 v[200:203], v245 offset:35008
ds_read_b128 v[204:207], v245 offset:35264
v_mov_b32 v36, 0
v_mov_b32 v37, 0
v_mov_b32 v38, 0
v_mov_b32 v39, 0
s_waitcnt lgkmcnt(8)
v_mov_b32 v32, v16
s_nop 1
v_max_f32_dpp v32, v32, v32 quad_perm:[1,0,3,2] row_mask:0xf bank_mask:0xf
s_nop 1
v_max_f32_dpp v32, v32, v32 quad_perm:[2,3,0,1] row_mask:0xf bank_mask:0xf
s_nop 1
v_max_f32_dpp v32, v32, v32 row_half_mirror row_mask:0xf bank_mask:0xf
s_nop 1
v_max_f32_dpp v32, v32, v32 row_mirror row_mask:0xf bank_mask:0xf
v_sub_f32 v16, v16, v32
v_mul_f32 v16, s10, v16
v_exp_f32 v16, v16
s_nop 0
v_mul_f32 v33, v16, v17
s_waitcnt lgkmcnt(7)
v_fmac_f32_dpp v36, v16, v176 row_newbcast:0 row_mask:0xf bank_mask:0xf
v_fmac_f32_dpp v37, v16, v177 row_newbcast:0 row_mask:0xf bank_mask:0xf
v_fmac_f32_dpp v38, v16, v178 row_newbcast:0 row_mask:0xf bank_mask:0xf
v_fmac_f32_dpp v39, v16, v179 row_newbcast:0 row_mask:0xf bank_mask:0xf
v_add_f32_dpp v33, v33, v33 quad_perm:[1,0,3,2] row_mask:0xf bank_mask:0xf
s_waitcnt lgkmcnt(6)
v_fmac_f32_dpp v36, v16, v180 row_newbcast:1 row_mask:0xf bank_mask:0xf
v_fmac_f32_dpp v37, v16, v181 row_newbcast:1 row_mask:0xf bank_mask:0xf
v_fmac_f32_dpp v38, v16, v182 row_newbcast:1 row_mask:0xf bank_mask:0xf
v_fmac_f32_dpp v39, v16, v183 row_newbcast:1 row_mask:0xf bank_mask:0xf
v_add_f32_dpp v33, v33, v33 quad_perm:[2,3,0,1] row_mask:0xf bank_mask:0xf
s_waitcnt lgkmcnt(5)
v_fmac_f32_dpp v36, v16, v184 row_newbcast:2 row_mask:0xf bank_mask:0xf
v_fmac_f32_dpp v37, v16, v185 row_newbcast:2 row_mask:0xf bank_mask:0xf
v_fmac_f32_dpp v38, v16, v186 row_newbcast:2 row_mask:0xf bank_mask:0xf
v_fmac_f32_dpp v39, v16, v187 row_newbcast:2 row_mask:0xf bank_mask:0xf
v_add_f32_dpp v33, v33, v33 row_half_mirror row_mask:0xf bank_mask:0xf
s_waitcnt lgkmcnt(4)
v_fmac_f32_dpp v36, v16, v188 row_newbcast:3 row_mask:0xf bank_mask:0xf
v_fmac_f32_dpp v37, v16, v189 row_newbcast:3 row_mask:0xf bank_mask:0xf
v_fmac_f32_dpp v38, v16, v190 row_newbcast:3 row_mask:0xf bank_mask:0xf
v_fmac_f32_dpp v39, v16, v191 row_newbcast:3 row_mask:0xf bank_mask:0xf
v_add_f32_dpp v33, v33, v33 row_mirror row_mask:0xf bank_mask:0xf
s_waitcnt lgkmcnt(3)
v_fmac_f32_dpp v36, v16, v192 row_newbcast:4 row_mask:0xf bank_mask:0xf
v_fmac_f32_dpp v37, v16, v193 row_newbcast:4 row_mask:0xf bank_mask:0xf
v_fmac_f32_dpp v38, v16, v194 row_newbcast:4 row_mask:0xf bank_mask:0xf
v_fmac_f32_dpp v39, v16, v195 row_newbcast:4 row_mask:0xf bank_mask:0xf
v_log_f32 v34, v33
v_rcp_f32 v33, v33
s_waitcnt lgkmcnt(2)
v_fmac_f32_dpp v36, v16, v196 row_newbcast:5 row_mask:0xf bank_mask:0xf
v_fmac_f32_dpp v37, v16, v197 row_newbcast:5 row_mask:0xf bank_mask:0xf
v_fmac_f32_dpp v38, v16, v198 row_newbcast:5 row_mask:0xf bank_mask:0xf
v_fmac_f32_dpp v39, v16, v199 row_newbcast:5 row_mask:0xf bank_mask:0xf
v_fmac_f32 v34, s10, v32
s_waitcnt lgkmcnt(1)
v_fmac_f32_dpp v36, v16, v200 row_newbcast:6 row_mask:0xf bank_mask:0xf
v_fmac_f32_dpp v37, v16, v201 row_newbcast:6 row_mask:0xf bank_mask:0xf
v_fmac_f32_dpp v38, v16, v202 row_newbcast:6 row_mask:0xf bank_mask:0xf
v_fmac_f32_dpp v39, v16, v203 row_newbcast:6 row_mask:0xf bank_mask:0xf
s_waitcnt lgkmcnt(0)
v_fmac_f32_dpp v36, v16, v204 row_newbcast:7 row_mask:0xf bank_mask:0xf
v_fmac_f32_dpp v37, v16, v205 row_newbcast:7 row_mask:0xf bank_mask:0xf
v_fmac_f32_dpp v38, v16, v206 row_newbcast:7 row_mask:0xf bank_mask:0xf
v_fmac_f32_dpp v39, v16, v207 row_newbcast:7 row_mask:0xf bank_mask:0xf
v_lshrrev_b32 v34, v246, v34
v_mov_b32 v40, v36
v_mov_b32 v41, v37
v_mov_b32 v42, v38
v_mov_b32 v43, v39
v_permlane32_swap_b32 v36, v40
v_permlane32_swap_b32 v37, v41
v_permlane32_swap_b32 v38, v42
v_permlane32_swap_b32 v39, v43
s_nop 0
v_add_f32 v36, v36, v40
v_add_f32 v37, v37, v41
v_add_f32 v38, v38, v42
v_add_f32 v39, v39, v43
v_mul_f32 v36, v36, v33
v_mul_f32 v37, v37, v33
v_mul_f32 v38, v38, v33
v_mul_f32 v39, v39, v33
s_mov_b32 s58, 0xffffffc0
v_min_u32 v36, s58, v36
v_min_u32 v37, s58, v37
v_min_u32 v38, s58, v38
v_min_u32 v39, s58, v39
v_bfi_b32 v36, 15, v34, v36
v_lshrrev_b32 v34, 4, v34
v_bfi_b32 v37, 15, v34, v37
v_lshrrev_b32 v34, 4, v34
v_bfi_b32 v38, 15, v34, v38
v_lshrrev_b32 v34, 4, v34
v_bfi_b32 v39, 15, v34, v39
s_mov_b32 exec_hi, 0
buffer_store_dwordx4 v[36:39], v244, s[48:51], s82 offen sc1
s_mov_b64 exec, -1
.LstageB:
v_lshlrev_b32 v8, 4, v0
v_and_b32 v12, 3, v0
s_lshr_b32 s61, s2, 3
s_add_u32 s53, s61, 5
s_xor_b32 s53, s53, s2
s_and_b32 s53, s53, 7
s_cmp_ge_u32 s2, 224
s_cselect_b32 s53, 1, s53
s_add_u32 s54, s6, 1
s_and_b32 s54, s54, 3
s_mul_i32 s55, s61, 16384
s_lshl_b32 s58, s54, 12
s_add_u32 s55, s55, s58
s_add_u32 s55, s55, 1048576
v_lshrrev_b32 v5, 5, v0
v_bfe_u32 v6, v0, 4, 1
v_lshlrev_b32 v4, 2, v12
v_lshl_add_u32 v4, v5, 1, v4
v_add_u32 v4, v4, v6
v_lshlrev_b32 v5, 1, v4
v_lshlrev_b32 v4, 2, v4
s_lshl_b32 s58, s54, 6
v_add_u32 v6, s58, v4
v_and_b32 v7, 12, v0
v_cmp_eq_u32 s[68:69], 0, v7
s_mov_b32 s64, s34
s_mov_b32 s65, s35
s_mov_b32 s66, 0x380
s_mov_b32 s67, 0x20000
s_lshl_b32 s60, s61, 5
s_cmp_lg_u32 s53, 0
s_cbranch_scc1 .Lsend
ds_read_b32 v27, v4 offset:1280
ds_read_b32 v28, v4 offset:1344
s_mov_b32 s58, 0
.LpollB:
buffer_load_dwordx4 v[176:179], v8, s[48:51], s55 offen offset:0 sc1
buffer_load_dwordx4 v[180:183], v8, s[48:51], s55 offen offset:1024 sc1
buffer_load_dwordx4 v[184:187], v8, s[48:51], s55 offen offset:2048 sc1
buffer_load_dwordx4 v[188:191], v8, s[48:51], s55 offen offset:3072 sc1
s_waitcnt vmcnt(0)
v_max_u32 v16, v176, v177
v_max3_u32 v16, v16, v178, v179
v_max3_u32 v16, v16, v180, v181
v_max3_u32 v16, v16, v182, v183
v_max3_u32 v16, v16, v184, v185
v_max3_u32 v16, v16, v186, v187
v_max3_u32 v16, v16, v188, v189
v_max3_u32 v16, v16, v190, v191
v_cmp_eq_u32 vcc, -1, v16
s_add_u32 s58, s58, 1
s_cbranch_vccz .LpollB_done
s_mov_b64 exec, vcc
s_cmp_lt_u32 s58, 100000
s_cbranch_scc1 .LpollB
.LpollB_done:
s_mov_b64 exec, -1
v_add_f32 v208, v176, v180
v_add_f32 v209, v177, v181
v_add_f32 v210, v178, v182
v_add_f32 v211, v179, v183
v_add_f32 v212, v184, v188
v_add_f32 v213, v185, v189
v_add_f32 v214, v186, v190
v_add_f32 v215, v187, v191
v_add_f32 v208, v208, v212
v_add_f32 v209, v209, v213
v_add_f32 v210, v210, v214
v_add_f32 v211, v211, v215
s_nop 0
v_permlane32_swap_b32 v208, v210
v_permlane32_swap_b32 v209, v211
s_nop 1
v_add_f32 v208, v208, v210
v_add_f32 v209, v209, v211
s_nop 1
v_permlane16_swap_b32 v208, v209
s_nop 1
v_add_f32 v20, v208, v209
s_nop 1
v_add_f32_dpp v20, v20, v20 row_ror:4 row_mask:0xf bank_mask:0xf
s_nop 1
v_add_f32_dpp v20, v20, v20 row_ror:8 row_mask:0xf bank_mask:0xf
ds_write_b32 v6, v20 offset:1024
s_waitcnt lgkmcnt(0)
s_barrier
s_cmp_eq_u32 s6, 6
s_cbranch_scc0 .Lsend
ds_read_b32 v20, v4 offset:1024
ds_read_b32 v21, v4 offset:1088
ds_read_b32 v22, v4 offset:1152
ds_read_b32 v23, v4 offset:1216
s_waitcnt lgkmcnt(0)
v_add_f32 v20, v20, v21
v_add_f32 v22, v22, v23
v_add_f32 v20, v20, v22
v_cvt_pk_bf16_f32 v20, v20, v20
v_lshlrev_b32 v20, 16, v20
v_add_f32 v20, v28, v20
v_cvt_pk_bf16_f32 v20, v20, v20
v_lshlrev_b32 v20, 16, v20
v_add_f32 v20, v20, v27
v_cvt_pk_bf16_f32 v20, v20, v20
s_mov_b64 exec, s[68:69]
buffer_store_short v20, v5, s[64:67], s60 offen
s_mov_b64 exec, -1
.Lsend:
s_endpgm
.Lhelper:
s_setprio 3
v_lshrrev_b32 v2, 3, v0
v_and_b32 v3, 7, v0
v_lshlrev_b32 v8, 4, v0
v_mov_b32 v9, 0
v_lshlrev_b32 v10, 2, v0
s_lshr_b32 s66, s5, 3
s_and_b32 s67, s5, 7
s_mul_i32 s62, s66, 112
s_lshl_b32 s63, s62, 13
s_lshl_b32 s68, s4, 9
s_lshl_b32 s69, s67, 6
s_add_u32 s68, s68, s69
s_lshl_b32 s69, s68, 1
s_add_u32 s63, s63, s69
s_mov_b32 s64, 114688
v_mul_lo_u32 v11, v2, s64
v_lshl_add_u32 v11, v3, 4, v11
v_mul_u32_u24 v12, 28, v2
s_lshl_b32 s65, s62, 1
s_waitcnt lgkmcnt(0)
s_mov_b32 s40, s16
s_mov_b32 s41, s17
s_mov_b32 s42, 0x380
s_mov_b32 s43, 0x20000
s_mov_b32 s44, s22
s_mov_b32 s45, s23
s_mov_b32 s46, 0x380000
s_mov_b32 s47, 0x20000
buffer_load_dwordx4 v[4:7], v8, s[40:43], 0 offen
buffer_load_dwordx4 v[40:43], v12, s[40:43], s65 offen
buffer_load_dwordx4 v[44:47], v12, s[40:43], s65 offen offset:16
buffer_load_dwordx4 v[64:67], v11, s[44:47], s63 offen nt
s_add_u32 s63, s63, 8192
buffer_load_dwordx4 v[68:71], v11, s[44:47], s63 offen nt
s_add_u32 s63, s63, 8192
buffer_load_dwordx4 v[72:75], v11, s[44:47], s63 offen nt
s_add_u32 s63, s63, 8192
buffer_load_dwordx4 v[76:79], v11, s[44:47], s63 offen nt
s_add_u32 s63, s63, 8192
buffer_load_dwordx4 v[80:83], v11, s[44:47], s63 offen nt
s_add_u32 s63, s63, 8192
buffer_load_dwordx4 v[84:87], v11, s[44:47], s63 offen nt
s_add_u32 s63, s63, 8192
buffer_load_dwordx4 v[88:91], v11, s[44:47], s63 offen nt
s_add_u32 s63, s63, 8192
buffer_load_dwordx4 v[92:95], v11, s[44:47], s63 offen nt
s_add_u32 s63, s63, 8192
buffer_load_dwordx4 v[96:99], v11, s[44:47], s63 offen nt
s_add_u32 s63, s63, 8192
buffer_load_dwordx4 v[100:103], v11, s[44:47], s63 offen nt
s_add_u32 s63, s63, 8192
buffer_load_dwordx4 v[104:107], v11, s[44:47], s63 offen nt
s_add_u32 s63, s63, 8192
buffer_load_dwordx4 v[108:111], v11, s[44:47], s63 offen nt
s_add_u32 s63, s63, 8192
buffer_load_dwordx4 v[112:115], v11, s[44:47], s63 offen nt
s_add_u32 s63, s63, 8192
buffer_load_dwordx4 v[116:119], v11, s[44:47], s63 offen nt
s_add_u32 s63, s63, 8192
s_barrier
s_mov_b32 s48, s38
s_mov_b32 s49, s39
s_mov_b32 s50, 0x260000
s_mov_b32 s51, 0x20000
s_mov_b32 s52, s36
s_mov_b32 s53, s37
s_mov_b32 s54, 0x100
s_mov_b32 s55, 0x20000
s_waitcnt vmcnt(16)
buffer_load_dword v48, v9, s[52:55], 0 offen sc1
v_lshlrev_b32 v16, 16, v4
v_and_b32 v17, 0xffff0000, v4
v_lshlrev_b32 v18, 16, v5
v_and_b32 v19, 0xffff0000, v5
v_lshlrev_b32 v20, 16, v6
v_and_b32 v21, 0xffff0000, v6
v_lshlrev_b32 v22, 16, v7
v_and_b32 v23, 0xffff0000, v7
v_add_f32 v13, v16, v17
v_add_f32 v13, v13, v18
v_add_f32 v13, v13, v19
v_add_f32 v13, v13, v20
v_add_f32 v13, v13, v21
v_add_f32 v13, v13, v22
v_add_f32 v13, v13, v23
s_nop 1
v_add_f32_dpp v13, v13, v13 quad_perm:[1,0,3,2] row_mask:0xf bank_mask:0xf
s_nop 1
v_add_f32_dpp v13, v13, v13 quad_perm:[2,3,0,1] row_mask:0xf bank_mask:0xf
s_nop 1
v_add_f32_dpp v13, v13, v13 row_half_mirror row_mask:0xf bank_mask:0xf
s_nop 1
v_add_f32_dpp v13, v13, v13 row_mirror row_mask:0xf bank_mask:0xf
v_mov_b32 v14, v13
s_nop 1
v_permlane16_swap_b32 v13, v14
s_nop 1
v_add_f32 v13, v13, v14
v_mov_b32 v14, v13
s_nop 1
v_permlane32_swap_b32 v13, v14
s_nop 1
v_add_f32 v13, v13, v14
v_mul_f32 v13, 0x3b124925, v13
v_sub_f32 v16, v16, v13
v_sub_f32 v17, v17, v13
v_sub_f32 v18, v18, v13
v_sub_f32 v19, v19, v13
v_sub_f32 v20, v20, v13
v_sub_f32 v21, v21, v13
v_sub_f32 v22, v22, v13
v_sub_f32 v23, v23, v13
v_mul_f32 v14, v16, v16
v_fmac_f32 v14, v17, v17
v_fmac_f32 v14, v18, v18
v_fmac_f32 v14, v19, v19
v_fmac_f32 v14, v20, v20
v_fmac_f32 v14, v21, v21
v_fmac_f32 v14, v22, v22
v_fmac_f32 v14, v23, v23
v_cmp_gt_u32 vcc, 56, v0
s_nop 1
v_cndmask_b32 v14, 0, v14, vcc
s_nop 1
v_add_f32_dpp v14, v14, v14 quad_perm:[1,0,3,2] row_mask:0xf bank_mask:0xf
s_nop 1
v_add_f32_dpp v14, v14, v14 quad_perm:[2,3,0,1] row_mask:0xf bank_mask:0xf
s_nop 1
v_add_f32_dpp v14, v14, v14 row_half_mirror row_mask:0xf bank_mask:0xf
s_nop 1
v_add_f32_dpp v14, v14, v14 row_mirror row_mask:0xf bank_mask:0xf
v_mov_b32 v15, v14
s_nop 1
v_permlane16_swap_b32 v14, v15
s_nop 1
v_add_f32 v14, v14, v15
v_mov_b32 v15, v14
s_nop 1
v_permlane32_swap_b32 v14, v15
s_nop 1
v_add_f32 v14, v14, v15
v_mul_f32 v14, 0x3b124925, v14
v_cvt_pk_bf16_f32 v15, v13, v14
v_lshlrev_b32 v13, 16, v15
v_and_b32 v14, 0xffff0000, v15
v_add_f32 v14, 0x3727c5ac, v14
v_cvt_pk_bf16_f32 v14, v14, v14
v_lshlrev_b32 v14, 16, v14
v_sqrt_f32 v14, v14
s_nop 0
v_cvt_pk_bf16_f32 v14, v14, v14
v_lshlrev_b32 v14, 16, v14
v_rcp_f32 v14, v14
s_waitcnt vmcnt(15)
v_lshlrev_b32 v16, 16, v40
v_and_b32 v17, 0xffff0000, v40
v_sub_f32 v16, v16, v13
v_sub_f32 v17, v17, v13
v_cvt_pk_bf16_f32 v18, v16, v17
v_lshlrev_b32 v16, 16, v18
v_and_b32 v17, 0xffff0000, v18
v_mul_f32 v16, v16, v14
v_mul_f32 v17, v17, v14
v_cvt_pk_bf16_f32 v32, v16, v17
v_lshlrev_b32 v16, 16, v41
v_and_b32 v17, 0xffff0000, v41
v_sub_f32 v16, v16, v13
v_sub_f32 v17, v17, v13
v_cvt_pk_bf16_f32 v18, v16, v17
v_lshlrev_b32 v16, 16, v18
v_and_b32 v17, 0xffff0000, v18
v_mul_f32 v16, v16, v14
v_mul_f32 v17, v17, v14
v_cvt_pk_bf16_f32 v33, v16, v17
v_lshlrev_b32 v16, 16, v42
v_and_b32 v17, 0xffff0000, v42
v_sub_f32 v16, v16, v13
v_sub_f32 v17, v17, v13
v_cvt_pk_bf16_f32 v18, v16, v17
v_lshlrev_b32 v16, 16, v18
v_and_b32 v17, 0xffff0000, v18
v_mul_f32 v16, v16, v14
v_mul_f32 v17, v17, v14
v_cvt_pk_bf16_f32 v34, v16, v17
v_lshlrev_b32 v16, 16, v43
v_and_b32 v17, 0xffff0000, v43
v_sub_f32 v16, v16, v13
v_sub_f32 v17, v17, v13
v_cvt_pk_bf16_f32 v18, v16, v17
v_lshlrev_b32 v16, 16, v18
v_and_b32 v17, 0xffff0000, v18
v_mul_f32 v16, v16, v14
v_mul_f32 v17, v17, v14
v_cvt_pk_bf16_f32 v35, v16, v17
v_lshlrev_b32 v16, 16, v44
v_and_b32 v17, 0xffff0000, v44
v_sub_f32 v16, v16, v13
v_sub_f32 v17, v17, v13
v_cvt_pk_bf16_f32 v18, v16, v17
v_lshlrev_b32 v16, 16, v18
v_and_b32 v17, 0xffff0000, v18
v_mul_f32 v16, v16, v14
v_mul_f32 v17, v17, v14
v_cvt_pk_bf16_f32 v36, v16, v17
v_lshlrev_b32 v16, 16, v45
v_and_b32 v17, 0xffff0000, v45
v_sub_f32 v16, v16, v13
v_sub_f32 v17, v17, v13
v_cvt_pk_bf16_f32 v18, v16, v17
v_lshlrev_b32 v16, 16, v18
v_and_b32 v17, 0xffff0000, v18
v_mul_f32 v16, v16, v14
v_mul_f32 v17, v17, v14
v_cvt_pk_bf16_f32 v37, v16, v17
v_lshlrev_b32 v16, 16, v46
v_and_b32 v17, 0xffff0000, v46
v_sub_f32 v16, v16, v13
v_sub_f32 v17, v17, v13
v_cvt_pk_bf16_f32 v18, v16, v17
v_lshlrev_b32 v16, 16, v18
v_and_b32 v17, 0xffff0000, v18
v_mul_f32 v16, v16, v14
v_mul_f32 v17, v17, v14
v_cvt_pk_bf16_f32 v38, v16, v17
v_mov_b32 v24, 0
v_mov_b32 v25, 0
v_mov_b32 v26, 0
v_mov_b32 v27, 0
v_mov_b32 v28, 0
v_mov_b32 v29, 0
v_mov_b32 v30, 0
v_mov_b32 v31, 0
v_lshrrev_b32 v16, 5, v0
v_bfe_u32 v17, v0, 4, 1
v_bfe_u32 v18, v0, 3, 1
v_lshlrev_b32 v49, 3, v3
v_lshl_add_u32 v49, v16, 2, v49
v_lshl_add_u32 v49, v17, 1, v49
v_add_u32 v49, v49, v18
v_lshlrev_b32 v49, 3, v49
s_waitcnt vmcnt(13)
v_perm_b32 v16, v68, v64, s8
v_perm_b32 v17, v68, v64, s9
v_dot2c_f32_bf16 v24, v16, v32
v_dot2c_f32_bf16 v25, v17, v32
v_perm_b32 v18, v69, v65, s8
v_perm_b32 v19, v69, v65, s9
v_dot2c_f32_bf16 v26, v18, v32
v_dot2c_f32_bf16 v27, v19, v32
v_perm_b32 v16, v70, v66, s8
v_perm_b32 v17, v70, v66, s9
v_dot2c_f32_bf16 v28, v16, v32
v_dot2c_f32_bf16 v29, v17, v32
v_perm_b32 v18, v71, v67, s8
v_perm_b32 v19, v71, v67, s9
v_dot2c_f32_bf16 v30, v18, v32
v_dot2c_f32_bf16 v31, v19, v32
s_waitcnt vmcnt(11)
v_perm_b32 v16, v76, v72, s8
v_perm_b32 v17, v76, v72, s9
v_dot2c_f32_bf16 v24, v16, v33
v_dot2c_f32_bf16 v25, v17, v33
v_perm_b32 v18, v77, v73, s8
v_perm_b32 v19, v77, v73, s9
v_dot2c_f32_bf16 v26, v18, v33
v_dot2c_f32_bf16 v27, v19, v33
v_perm_b32 v16, v78, v74, s8
v_perm_b32 v17, v78, v74, s9
v_dot2c_f32_bf16 v28, v16, v33
v_dot2c_f32_bf16 v29, v17, v33
v_perm_b32 v18, v79, v75, s8
v_perm_b32 v19, v79, v75, s9
v_dot2c_f32_bf16 v30, v18, v33
v_dot2c_f32_bf16 v31, v19, v33
s_waitcnt vmcnt(9)
v_perm_b32 v16, v84, v80, s8
v_perm_b32 v17, v84, v80, s9
v_dot2c_f32_bf16 v24, v16, v34
v_dot2c_f32_bf16 v25, v17, v34
v_perm_b32 v18, v85, v81, s8
v_perm_b32 v19, v85, v81, s9
v_dot2c_f32_bf16 v26, v18, v34
v_dot2c_f32_bf16 v27, v19, v34
v_perm_b32 v16, v86, v82, s8
v_perm_b32 v17, v86, v82, s9
v_dot2c_f32_bf16 v28, v16, v34
v_dot2c_f32_bf16 v29, v17, v34
v_perm_b32 v18, v87, v83, s8
v_perm_b32 v19, v87, v83, s9
v_dot2c_f32_bf16 v30, v18, v34
v_dot2c_f32_bf16 v31, v19, v34
s_waitcnt vmcnt(7)
v_perm_b32 v16, v92, v88, s8
v_perm_b32 v17, v92, v88, s9
v_dot2c_f32_bf16 v24, v16, v35
v_dot2c_f32_bf16 v25, v17, v35
v_perm_b32 v18, v93, v89, s8
v_perm_b32 v19, v93, v89, s9
v_dot2c_f32_bf16 v26, v18, v35
v_dot2c_f32_bf16 v27, v19, v35
v_perm_b32 v16, v94, v90, s8
v_perm_b32 v17, v94, v90, s9
v_dot2c_f32_bf16 v28, v16, v35
v_dot2c_f32_bf16 v29, v17, v35
v_perm_b32 v18, v95, v91, s8
v_perm_b32 v19, v95, v91, s9
v_dot2c_f32_bf16 v30, v18, v35
v_dot2c_f32_bf16 v31, v19, v35
s_waitcnt vmcnt(5)
v_perm_b32 v16, v100, v96, s8
v_perm_b32 v17, v100, v96, s9
v_dot2c_f32_bf16 v24, v16, v36
v_dot2c_f32_bf16 v25, v17, v36
v_perm_b32 v18, v101, v97, s8
v_perm_b32 v19, v101, v97, s9
v_dot2c_f32_bf16 v26, v18, v36
v_dot2c_f32_bf16 v27, v19, v36
v_perm_b32 v16, v102, v98, s8
v_perm_b32 v17, v102, v98, s9
v_dot2c_f32_bf16 v28, v16, v36
v_dot2c_f32_bf16 v29, v17, v36
v_perm_b32 v18, v103, v99, s8
v_perm_b32 v19, v103, v99, s9
v_dot2c_f32_bf16 v30, v18, v36
v_dot2c_f32_bf16 v31, v19, v36
s_waitcnt vmcnt(3)
v_perm_b32 v16, v108, v104, s8
v_perm_b32 v17, v108, v104, s9
v_dot2c_f32_bf16 v24, v16, v37
v_dot2c_f32_bf16 v25, v17, v37
v_perm_b32 v18, v109, v105, s8
v_perm_b32 v19, v109, v105, s9
v_dot2c_f32_bf16 v26, v18, v37
v_dot2c_f32_bf16 v27, v19, v37
v_perm_b32 v16, v110, v106, s8
v_perm_b32 v17, v110, v106, s9
v_dot2c_f32_bf16 v28, v16, v37
v_dot2c_f32_bf16 v29, v17, v37
v_perm_b32 v18, v111, v107, s8
v_perm_b32 v19, v111, v107, s9
v_dot2c_f32_bf16 v30, v18, v37
v_dot2c_f32_bf16 v31, v19, v37
s_waitcnt vmcnt(1)
v_perm_b32 v16, v116, v112, s8
v_perm_b32 v17, v116, v112, s9
v_dot2c_f32_bf16 v24, v16, v38
v_dot2c_f32_bf16 v25, v17, v38
v_perm_b32 v18, v117, v113, s8
v_perm_b32 v19, v117, v113, s9
v_dot2c_f32_bf16 v26, v18, v38
v_dot2c_f32_bf16 v27, v19, v38
v_perm_b32 v16, v118, v114, s8
v_perm_b32 v17, v118, v114, s9
v_dot2c_f32_bf16 v28, v16, v38
v_dot2c_f32_bf16 v29, v17, v38
v_perm_b32 v18, v119, v115, s8
v_perm_b32 v19, v119, v115, s9
v_dot2c_f32_bf16 v30, v18, v38
v_dot2c_f32_bf16 v31, v19, v38
v_permlane32_swap_b32 v24, v28
v_permlane32_swap_b32 v25, v29
v_permlane32_swap_b32 v26, v30
v_permlane32_swap_b32 v27, v31
s_nop 1
v_add_f32 v24, v24, v28
v_add_f32 v25, v25, v29
v_add_f32 v26, v26, v30
v_add_f32 v27, v27, v31
s_nop 0
v_permlane16_swap_b32 v24, v26
v_permlane16_swap_b32 v25, v27
s_nop 1
v_add_f32 v24, v24, v26
v_add_f32 v25, v25, v27
s_nop 0
v_add_f32_dpp v26, v24, v24 row_ror:8 row_mask:0xf bank_mask:0x3
v_add_f32_dpp v26, v25, v25 row_ror:8 row_mask:0xf bank_mask:0xc
s_lshl_b32 s69, s66, 15
s_lshl_b32 s68, s68, 3
s_add_u32 s69, s69, s68
s_add_u32 s69, s69, 786432
s_mov_b32 s71, 0
.Lep:
s_waitcnt vmcnt(0)
v_readfirstlane_b32 s72, v48
s_add_u32 s71, s71, 1
s_cmp_lg_u32 s72, 0
s_cbranch_scc1 .Lepd
buffer_load_dword v48, v9, s[52:55], 0 offen sc1
s_cmp_lt_u32 s71, 100000
s_cbranch_scc1 .Lep
.Lepd:
v_mov_b32 v27, s72
buffer_store_dwordx2 v[26:27], v49, s[48:51], s69 offen sc1
s_and_b32 s77, s2, 7
s_lshr_b32 s78, s2, 3
s_add_u32 s74, s78, 3
s_and_b32 s74, s74, 7
s_cmp_eq_u32 s77, s74
s_cselect_b32 s73, 1, 0
s_add_u32 s74, s78, 5
s_and_b32 s74, s74, 7
s_cmp_eq_u32 s77, s74
s_cselect_b32 s73, 2, s73
s_cmp_lt_u32 s2, 224
s_cselect_b32 s73, s73, 0
v_mov_b32 v52, -1
v_mov_b32 v53, -1
v_mov_b32 v54, -1
v_mov_b32 v55, -1
v_mov_b32 v51, 0x10000000
s_lshl_b32 s74, s2, 11
s_add_u32 s74, s74, 262144
buffer_store_dwordx4 v[52:55], v8, s[48:51], s74 offen sc1
buffer_store_dwordx4 v[52:55], v8, s[48:51], s74 offen offset:1024 sc1
s_lshl_b32 s74, s2, 11
s_add_u32 s74, s74, 1966080
buffer_store_dwordx4 v[52:55], v8, s[48:51], s74 offen sc1
buffer_store_dwordx4 v[52:55], v8, s[48:51], s74 offen offset:1024 sc1
s_mul_i32 s74, s78, 4352
s_cmp_eq_u32 s77, 0
s_cselect_b32 s74, s74, 0x10000000
s_mov_b64 exec, 1
buffer_store_dword v9, v9, s[48:51], s74 offen sc1
buffer_store_dword v9, v9, s[48:51], s74 offen offset:128 sc1
s_mov_b64 exec, -1
s_cmp_lg_u32 s73, 2
s_cbranch_scc1 .Lnoya
s_mul_i32 s74, s78, 16384
s_add_u32 s74, s74, 1048576
buffer_store_dwordx4 v[52:55], v8, s[48:51], s74 offen offset:0 sc1
buffer_store_dwordx4 v[52:55], v8, s[48:51], s74 offen offset:1024 sc1
buffer_store_dwordx4 v[52:55], v8, s[48:51], s74 offen offset:2048 sc1
buffer_store_dwordx4 v[52:55], v8, s[48:51], s74 offen offset:3072 sc1
s_add_u32 s74, s74, 4096
buffer_store_dwordx4 v[52:55], v8, s[48:51], s74 offen offset:0 sc1
buffer_store_dwordx4 v[52:55], v8, s[48:51], s74 offen offset:1024 sc1
buffer_store_dwordx4 v[52:55], v8, s[48:51], s74 offen offset:2048 sc1
buffer_store_dwordx4 v[52:55], v8, s[48:51], s74 offen offset:3072 sc1
s_add_u32 s74, s74, 4096
buffer_store_dwordx4 v[52:55], v8, s[48:51], s74 offen offset:0 sc1
buffer_store_dwordx4 v[52:55], v8, s[48:51], s74 offen offset:1024 sc1
buffer_store_dwordx4 v[52:55], v8, s[48:51], s74 offen offset:2048 sc1
buffer_store_dwordx4 v[52:55], v8, s[48:51], s74 offen offset:3072 sc1
s_add_u32 s74, s74, 4096
buffer_store_dwordx4 v[52:55], v8, s[48:51], s74 offen offset:0 sc1
buffer_store_dwordx4 v[52:55], v8, s[48:51], s74 offen offset:1024 sc1
buffer_store_dwordx4 v[52:55], v8, s[48:51], s74 offen offset:2048 sc1
buffer_store_dwordx4 v[52:55], v8, s[48:51], s74 offen offset:3072 sc1
s_add_u32 s74, s74, 4096
.Lnoya:
s_waitcnt vmcnt(0)
v_mov_b32 v16, s72
s_lshl_b32 s74, s2, 2
s_add_u32 s74, s74, 253952
s_mov_b64 exec, 1
buffer_store_dword v16, v9, s[48:51], s74 offen sc1
s_mov_b64 exec, -1
s_cmp_lg_u32 s73, 1
s_cbranch_scc1 .Lnoffn1
s_mov_b32 s44, s28
s_mov_b32 s45, s29
s_mov_b32 s46, 0x188000
s_mov_b32 s47, 0x20000
s_mov_b32 s56, s30
s_mov_b32 s57, s31
s_mov_b32 s58, 0x188000
s_mov_b32 s59, 0x20000
s_mov_b32 s64, s32
s_mov_b32 s65, s33
s_mov_b32 s66, 0x188000
s_mov_b32 s67, 0x20000
s_mov_b32 s60, 28672
v_mul_lo_u32 v11, v2, s60
v_lshl_add_u32 v11, v3, 4, v11
v_lshlrev_b32 v12, 4, v2
s_lshl_b32 s63, s78, 7
v_mov_b32 v24, 0
v_mov_b32 v56, 0
v_mov_b32 v25, 0
v_mov_b32 v57, 0
v_mov_b32 v26, 0
v_mov_b32 v58, 0
v_mov_b32 v27, 0
v_mov_b32 v59, 0
v_mov_b32 v28, 0
v_mov_b32 v60, 0
v_mov_b32 v29, 0
v_mov_b32 v61, 0
v_mov_b32 v30, 0
v_mov_b32 v62, 0
v_mov_b32 v31, 0
v_mov_b32 v63, 0
s_mov_b32 s61, 0
buffer_load_dwordx4 v[40:43], v12, s[40:43], s61 offen
s_add_u32 s61, s61, 128
buffer_load_dwordx4 v[64:67], v11, s[44:47], s63 offen nt
buffer_load_dwordx4 v[96:99], v11, s[56:59], s63 offen nt
s_add_u32 s63, s63, 3584
buffer_load_dwordx4 v[68:71], v11, s[44:47], s63 offen nt
buffer_load_dwordx4 v[100:103], v11, s[56:59], s63 offen nt
s_add_u32 s63, s63, 3584
buffer_load_dwordx4 v[72:75], v11, s[44:47], s63 offen nt
buffer_load_dwordx4 v[104:107], v11, s[56:59], s63 offen nt
s_add_u32 s63, s63, 3584
buffer_load_dwordx4 v[76:79], v11, s[44:47], s63 offen nt
buffer_load_dwordx4 v[108:111], v11, s[56:59], s63 offen nt
s_add_u32 s63, s63, 3584
buffer_load_dwordx4 v[80:83], v11, s[44:47], s63 offen nt
buffer_load_dwordx4 v[112:115], v11, s[56:59], s63 offen nt
s_add_u32 s63, s63, 3584
buffer_load_dwordx4 v[84:87], v11, s[44:47], s63 offen nt
buffer_load_dwordx4 v[116:119], v11, s[56:59], s63 offen nt
s_add_u32 s63, s63, 3584
buffer_load_dwordx4 v[88:91], v11, s[44:47], s63 offen nt
buffer_load_dwordx4 v[120:123], v11, s[56:59], s63 offen nt
s_add_u32 s63, s63, 3584
buffer_load_dwordx4 v[92:95], v11, s[44:47], s63 offen nt
buffer_load_dwordx4 v[124:127], v11, s[56:59], s63 offen nt
s_add_u32 s63, s63, 3584
s_add_u32 s63, s63, 200704
buffer_load_dwordx4 v[44:47], v12, s[40:43], s61 offen
s_add_u32 s61, s61, 128
buffer_load_dwordx4 v[128:131], v11, s[44:47], s63 offen nt
buffer_load_dwordx4 v[160:163], v11, s[56:59], s63 offen nt
s_add_u32 s63, s63, 3584
buffer_load_dwordx4 v[132:135], v11, s[44:47], s63 offen nt
buffer_load_dwordx4 v[164:167], v11, s[56:59], s63 offen nt
s_add_u32 s63, s63, 3584
buffer_load_dwordx4 v[136:139], v11, s[44:47], s63 offen nt
buffer_load_dwordx4 v[168:171], v11, s[56:59], s63 offen nt
s_add_u32 s63, s63, 3584
buffer_load_dwordx4 v[140:143], v11, s[44:47], s63 offen nt
buffer_load_dwordx4 v[172:175], v11, s[56:59], s63 offen nt
s_add_u32 s63, s63, 3584
buffer_load_dwordx4 v[144:147], v11, s[44:47], s63 offen nt
buffer_load_dwordx4 v[176:179], v11, s[56:59], s63 offen nt
s_add_u32 s63, s63, 3584
buffer_load_dwordx4 v[148:151], v11, s[44:47], s63 offen nt
buffer_load_dwordx4 v[180:183], v11, s[56:59], s63 offen nt
s_add_u32 s63, s63, 3584
buffer_load_dwordx4 v[152:155], v11, s[44:47], s63 offen nt
buffer_load_dwordx4 v[184:187], v11, s[56:59], s63 offen nt
s_add_u32 s63, s63, 3584
buffer_load_dwordx4 v[156:159], v11, s[44:47], s63 offen nt
buffer_load_dwordx4 v[188:191], v11, s[56:59], s63 offen nt
s_add_u32 s63, s63, 3584
s_add_u32 s63, s63, 200704
s_mov_b32 s62, 0
.Lffnloop:
s_waitcnt vmcnt(33)
v_lshlrev_b32 v16, 16, v40
v_and_b32 v17, 0xffff0000, v40
v_sub_f32 v16, v16, v13
v_sub_f32 v17, v17, v13
v_cvt_pk_bf16_f32 v18, v16, v17
v_lshlrev_b32 v16, 16, v18
v_and_b32 v17, 0xffff0000, v18
v_mul_f32 v16, v16, v14
v_mul_f32 v17, v17, v14
v_cvt_pk_bf16_f32 v32, v16, v17
v_lshlrev_b32 v16, 16, v41
v_and_b32 v17, 0xffff0000, v41
v_sub_f32 v16, v16, v13
v_sub_f32 v17, v17, v13
v_cvt_pk_bf16_f32 v18, v16, v17
v_lshlrev_b32 v16, 16, v18
v_and_b32 v17, 0xffff0000, v18
v_mul_f32 v16, v16, v14
v_mul_f32 v17, v17, v14
v_cvt_pk_bf16_f32 v33, v16, v17
v_lshlrev_b32 v16, 16, v42
v_and_b32 v17, 0xffff0000, v42
v_sub_f32 v16, v16, v13
v_sub_f32 v17, v17, v13
v_cvt_pk_bf16_f32 v18, v16, v17
v_lshlrev_b32 v16, 16, v18
v_and_b32 v17, 0xffff0000, v18
v_mul_f32 v16, v16, v14
v_mul_f32 v17, v17, v14
v_cvt_pk_bf16_f32 v34, v16, v17
v_lshlrev_b32 v16, 16, v43
v_and_b32 v17, 0xffff0000, v43
v_sub_f32 v16, v16, v13
v_sub_f32 v17, v17, v13
v_cvt_pk_bf16_f32 v18, v16, v17
v_lshlrev_b32 v16, 16, v18
v_and_b32 v17, 0xffff0000, v18
v_mul_f32 v16, v16, v14
v_mul_f32 v17, v17, v14
v_cvt_pk_bf16_f32 v35, v16, v17
buffer_load_dwordx4 v[40:43], v12, s[40:43], s61 offen
s_add_u32 s61, s61, 128
s_waitcnt vmcnt(30)
v_perm_b32 v16, v68, v64, s8
v_perm_b32 v17, v68, v64, s9
v_dot2c_f32_bf16 v24, v16, v32
v_dot2c_f32_bf16 v25, v17, v32
v_perm_b32 v18, v69, v65, s8
v_perm_b32 v19, v69, v65, s9
v_dot2c_f32_bf16 v26, v18, v32
v_dot2c_f32_bf16 v27, v19, v32
v_perm_b32 v16, v70, v66, s8
v_perm_b32 v17, v70, v66, s9
v_dot2c_f32_bf16 v28, v16, v32
v_dot2c_f32_bf16 v29, v17, v32
v_perm_b32 v18, v71, v67, s8
v_perm_b32 v19, v71, v67, s9
v_dot2c_f32_bf16 v30, v18, v32
v_dot2c_f32_bf16 v31, v19, v32
v_perm_b32 v16, v100, v96, s8
v_perm_b32 v17, v100, v96, s9
v_dot2c_f32_bf16 v56, v16, v32
v_dot2c_f32_bf16 v57, v17, v32
v_perm_b32 v18, v101, v97, s8
v_perm_b32 v19, v101, v97, s9
v_dot2c_f32_bf16 v58, v18, v32
v_dot2c_f32_bf16 v59, v19, v32
v_perm_b32 v16, v102, v98, s8
v_perm_b32 v17, v102, v98, s9
v_dot2c_f32_bf16 v60, v16, v32
v_dot2c_f32_bf16 v61, v17, v32
v_perm_b32 v18, v103, v99, s8
v_perm_b32 v19, v103, v99, s9
v_dot2c_f32_bf16 v62, v18, v32
v_dot2c_f32_bf16 v63, v19, v32
buffer_load_dwordx4 v[64:67], v11, s[44:47], s63 offen nt
buffer_load_dwordx4 v[96:99], v11, s[56:59], s63 offen nt
s_add_u32 s63, s63, 3584
buffer_load_dwordx4 v[68:71], v11, s[44:47], s63 offen nt
buffer_load_dwordx4 v[100:103], v11, s[56:59], s63 offen nt
s_add_u32 s63, s63, 3584
s_waitcnt vmcnt(30)
v_perm_b32 v16, v76, v72, s8
v_perm_b32 v17, v76, v72, s9
v_dot2c_f32_bf16 v24, v16, v33
v_dot2c_f32_bf16 v25, v17, v33
v_perm_b32 v18, v77, v73, s8
v_perm_b32 v19, v77, v73, s9
v_dot2c_f32_bf16 v26, v18, v33
v_dot2c_f32_bf16 v27, v19, v33
v_perm_b32 v16, v78, v74, s8
v_perm_b32 v17, v78, v74, s9
v_dot2c_f32_bf16 v28, v16, v33
v_dot2c_f32_bf16 v29, v17, v33
v_perm_b32 v18, v79, v75, s8
v_perm_b32 v19, v79, v75, s9
v_dot2c_f32_bf16 v30, v18, v33
v_dot2c_f32_bf16 v31, v19, v33
v_perm_b32 v16, v108, v104, s8
v_perm_b32 v17, v108, v104, s9
v_dot2c_f32_bf16 v56, v16, v33
v_dot2c_f32_bf16 v57, v17, v33
v_perm_b32 v18, v109, v105, s8
v_perm_b32 v19, v109, v105, s9
v_dot2c_f32_bf16 v58, v18, v33
v_dot2c_f32_bf16 v59, v19, v33
v_perm_b32 v16, v110, v106, s8
v_perm_b32 v17, v110, v106, s9
v_dot2c_f32_bf16 v60, v16, v33
v_dot2c_f32_bf16 v61, v17, v33
v_perm_b32 v18, v111, v107, s8
v_perm_b32 v19, v111, v107, s9
v_dot2c_f32_bf16 v62, v18, v33
v_dot2c_f32_bf16 v63, v19, v33
buffer_load_dwordx4 v[72:75], v11, s[44:47], s63 offen nt
buffer_load_dwordx4 v[104:107], v11, s[56:59], s63 offen nt
s_add_u32 s63, s63, 3584
buffer_load_dwordx4 v[76:79], v11, s[44:47], s63 offen nt
buffer_load_dwordx4 v[108:111], v11, s[56:59], s63 offen nt
s_add_u32 s63, s63, 3584
s_waitcnt vmcnt(30)
v_perm_b32 v16, v84, v80, s8
v_perm_b32 v17, v84, v80, s9
v_dot2c_f32_bf16 v24, v16, v34
v_dot2c_f32_bf16 v25, v17, v34
v_perm_b32 v18, v85, v81, s8
v_perm_b32 v19, v85, v81, s9
v_dot2c_f32_bf16 v26, v18, v34
v_dot2c_f32_bf16 v27, v19, v34
v_perm_b32 v16, v86, v82, s8
v_perm_b32 v17, v86, v82, s9
v_dot2c_f32_bf16 v28, v16, v34
v_dot2c_f32_bf16 v29, v17, v34
v_perm_b32 v18, v87, v83, s8
v_perm_b32 v19, v87, v83, s9
v_dot2c_f32_bf16 v30, v18, v34
v_dot2c_f32_bf16 v31, v19, v34
v_perm_b32 v16, v116, v112, s8
v_perm_b32 v17, v116, v112, s9
v_dot2c_f32_bf16 v56, v16, v34
v_dot2c_f32_bf16 v57, v17, v34
v_perm_b32 v18, v117, v113, s8
v_perm_b32 v19, v117, v113, s9
v_dot2c_f32_bf16 v58, v18, v34
v_dot2c_f32_bf16 v59, v19, v34
v_perm_b32 v16, v118, v114, s8
v_perm_b32 v17, v118, v114, s9
v_dot2c_f32_bf16 v60, v16, v34
v_dot2c_f32_bf16 v61, v17, v34
v_perm_b32 v18, v119, v115, s8
v_perm_b32 v19, v119, v115, s9
v_dot2c_f32_bf16 v62, v18, v34
v_dot2c_f32_bf16 v63, v19, v34
buffer_load_dwordx4 v[80:83], v11, s[44:47], s63 offen nt
buffer_load_dwordx4 v[112:115], v11, s[56:59], s63 offen nt
s_add_u32 s63, s63, 3584
buffer_load_dwordx4 v[84:87], v11, s[44:47], s63 offen nt
buffer_load_dwordx4 v[116:119], v11, s[56:59], s63 offen nt
s_add_u32 s63, s63, 3584
s_waitcnt vmcnt(30)
v_perm_b32 v16, v92, v88, s8
v_perm_b32 v17, v92, v88, s9
v_dot2c_f32_bf16 v24, v16, v35
v_dot2c_f32_bf16 v25, v17, v35
v_perm_b32 v18, v93, v89, s8
v_perm_b32 v19, v93, v89, s9
v_dot2c_f32_bf16 v26, v18, v35
v_dot2c_f32_bf16 v27, v19, v35
v_perm_b32 v16, v94, v90, s8
v_perm_b32 v17, v94, v90, s9
v_dot2c_f32_bf16 v28, v16, v35
v_dot2c_f32_bf16 v29, v17, v35
v_perm_b32 v18, v95, v91, s8
v_perm_b32 v19, v95, v91, s9
v_dot2c_f32_bf16 v30, v18, v35
v_dot2c_f32_bf16 v31, v19, v35
v_perm_b32 v16, v124, v120, s8
v_perm_b32 v17, v124, v120, s9
v_dot2c_f32_bf16 v56, v16, v35
v_dot2c_f32_bf16 v57, v17, v35
v_perm_b32 v18, v125, v121, s8
v_perm_b32 v19, v125, v121, s9
v_dot2c_f32_bf16 v58, v18, v35
v_dot2c_f32_bf16 v59, v19, v35
v_perm_b32 v16, v126, v122, s8
v_perm_b32 v17, v126, v122, s9
v_dot2c_f32_bf16 v60, v16, v35
v_dot2c_f32_bf16 v61, v17, v35
v_perm_b32 v18, v127, v123, s8
v_perm_b32 v19, v127, v123, s9
v_dot2c_f32_bf16 v62, v18, v35
v_dot2c_f32_bf16 v63, v19, v35
buffer_load_dwordx4 v[88:91], v11, s[44:47], s63 offen nt
buffer_load_dwordx4 v[120:123], v11, s[56:59], s63 offen nt
s_add_u32 s63, s63, 3584
buffer_load_dwordx4 v[92:95], v11, s[44:47], s63 offen nt
buffer_load_dwordx4 v[124:127], v11, s[56:59], s63 offen nt
s_add_u32 s63, s63, 3584
s_add_u32 s63, s63, 200704
s_cmp_eq_u32 s62, 3
s_cbranch_scc1 .Lffndone
s_waitcnt vmcnt(33)
v_lshlrev_b32 v16, 16, v44
v_and_b32 v17, 0xffff0000, v44
v_sub_f32 v16, v16, v13
v_sub_f32 v17, v17, v13
v_cvt_pk_bf16_f32 v18, v16, v17
v_lshlrev_b32 v16, 16, v18
v_and_b32 v17, 0xffff0000, v18
v_mul_f32 v16, v16, v14
v_mul_f32 v17, v17, v14
v_cvt_pk_bf16_f32 v32, v16, v17
v_lshlrev_b32 v16, 16, v45
v_and_b32 v17, 0xffff0000, v45
v_sub_f32 v16, v16, v13
v_sub_f32 v17, v17, v13
v_cvt_pk_bf16_f32 v18, v16, v17
v_lshlrev_b32 v16, 16, v18
v_and_b32 v17, 0xffff0000, v18
v_mul_f32 v16, v16, v14
v_mul_f32 v17, v17, v14
v_cvt_pk_bf16_f32 v33, v16, v17
v_lshlrev_b32 v16, 16, v46
v_and_b32 v17, 0xffff0000, v46
v_sub_f32 v16, v16, v13
v_sub_f32 v17, v17, v13
v_cvt_pk_bf16_f32 v18, v16, v17
v_lshlrev_b32 v16, 16, v18
v_and_b32 v17, 0xffff0000, v18
v_mul_f32 v16, v16, v14
v_mul_f32 v17, v17, v14
v_cvt_pk_bf16_f32 v34, v16, v17
v_lshlrev_b32 v16, 16, v47
v_and_b32 v17, 0xffff0000, v47
v_sub_f32 v16, v16, v13
v_sub_f32 v17, v17, v13
v_cvt_pk_bf16_f32 v18, v16, v17
v_lshlrev_b32 v16, 16, v18
v_and_b32 v17, 0xffff0000, v18
v_mul_f32 v16, v16, v14
v_mul_f32 v17, v17, v14
v_cvt_pk_bf16_f32 v35, v16, v17
buffer_load_dwordx4 v[44:47], v12, s[40:43], s61 offen
s_add_u32 s61, s61, 128
s_waitcnt vmcnt(30)
v_perm_b32 v16, v132, v128, s8
v_perm_b32 v17, v132, v128, s9
v_dot2c_f32_bf16 v24, v16, v32
v_dot2c_f32_bf16 v25, v17, v32
v_perm_b32 v18, v133, v129, s8
v_perm_b32 v19, v133, v129, s9
v_dot2c_f32_bf16 v26, v18, v32
v_dot2c_f32_bf16 v27, v19, v32
v_perm_b32 v16, v134, v130, s8
v_perm_b32 v17, v134, v130, s9
v_dot2c_f32_bf16 v28, v16, v32
v_dot2c_f32_bf16 v29, v17, v32
v_perm_b32 v18, v135, v131, s8
v_perm_b32 v19, v135, v131, s9
v_dot2c_f32_bf16 v30, v18, v32
v_dot2c_f32_bf16 v31, v19, v32
v_perm_b32 v16, v164, v160, s8
v_perm_b32 v17, v164, v160, s9
v_dot2c_f32_bf16 v56, v16, v32
v_dot2c_f32_bf16 v57, v17, v32
v_perm_b32 v18, v165, v161, s8
v_perm_b32 v19, v165, v161, s9
v_dot2c_f32_bf16 v58, v18, v32
v_dot2c_f32_bf16 v59, v19, v32
v_perm_b32 v16, v166, v162, s8
v_perm_b32 v17, v166, v162, s9
v_dot2c_f32_bf16 v60, v16, v32
v_dot2c_f32_bf16 v61, v17, v32
v_perm_b32 v18, v167, v163, s8
v_perm_b32 v19, v167, v163, s9
v_dot2c_f32_bf16 v62, v18, v32
v_dot2c_f32_bf16 v63, v19, v32
buffer_load_dwordx4 v[128:131], v11, s[44:47], s63 offen nt
buffer_load_dwordx4 v[160:163], v11, s[56:59], s63 offen nt
s_add_u32 s63, s63, 3584
buffer_load_dwordx4 v[132:135], v11, s[44:47], s63 offen nt
buffer_load_dwordx4 v[164:167], v11, s[56:59], s63 offen nt
s_add_u32 s63, s63, 3584
s_waitcnt vmcnt(30)
v_perm_b32 v16, v140, v136, s8
v_perm_b32 v17, v140, v136, s9
v_dot2c_f32_bf16 v24, v16, v33
v_dot2c_f32_bf16 v25, v17, v33
v_perm_b32 v18, v141, v137, s8
v_perm_b32 v19, v141, v137, s9
v_dot2c_f32_bf16 v26, v18, v33
v_dot2c_f32_bf16 v27, v19, v33
v_perm_b32 v16, v142, v138, s8
v_perm_b32 v17, v142, v138, s9
v_dot2c_f32_bf16 v28, v16, v33
v_dot2c_f32_bf16 v29, v17, v33
v_perm_b32 v18, v143, v139, s8
v_perm_b32 v19, v143, v139, s9
v_dot2c_f32_bf16 v30, v18, v33
v_dot2c_f32_bf16 v31, v19, v33
v_perm_b32 v16, v172, v168, s8
v_perm_b32 v17, v172, v168, s9
v_dot2c_f32_bf16 v56, v16, v33
v_dot2c_f32_bf16 v57, v17, v33
v_perm_b32 v18, v173, v169, s8
v_perm_b32 v19, v173, v169, s9
v_dot2c_f32_bf16 v58, v18, v33
v_dot2c_f32_bf16 v59, v19, v33
v_perm_b32 v16, v174, v170, s8
v_perm_b32 v17, v174, v170, s9
v_dot2c_f32_bf16 v60, v16, v33
v_dot2c_f32_bf16 v61, v17, v33
v_perm_b32 v18, v175, v171, s8
v_perm_b32 v19, v175, v171, s9
v_dot2c_f32_bf16 v62, v18, v33
v_dot2c_f32_bf16 v63, v19, v33
buffer_load_dwordx4 v[136:139], v11, s[44:47], s63 offen nt
buffer_load_dwordx4 v[168:171], v11, s[56:59], s63 offen nt
s_add_u32 s63, s63, 3584
buffer_load_dwordx4 v[140:143], v11, s[44:47], s63 offen nt
buffer_load_dwordx4 v[172:175], v11, s[56:59], s63 offen nt
s_add_u32 s63, s63, 3584
s_waitcnt vmcnt(30)
v_perm_b32 v16, v148, v144, s8
v_perm_b32 v17, v148, v144, s9
v_dot2c_f32_bf16 v24, v16, v34
v_dot2c_f32_bf16 v25, v17, v34
v_perm_b32 v18, v149, v145, s8
v_perm_b32 v19, v149, v145, s9
v_dot2c_f32_bf16 v26, v18, v34
v_dot2c_f32_bf16 v27, v19, v34
v_perm_b32 v16, v150, v146, s8
v_perm_b32 v17, v150, v146, s9
v_dot2c_f32_bf16 v28, v16, v34
v_dot2c_f32_bf16 v29, v17, v34
v_perm_b32 v18, v151, v147, s8
v_perm_b32 v19, v151, v147, s9
v_dot2c_f32_bf16 v30, v18, v34
v_dot2c_f32_bf16 v31, v19, v34
v_perm_b32 v16, v180, v176, s8
v_perm_b32 v17, v180, v176, s9
v_dot2c_f32_bf16 v56, v16, v34
v_dot2c_f32_bf16 v57, v17, v34
v_perm_b32 v18, v181, v177, s8
v_perm_b32 v19, v181, v177, s9
v_dot2c_f32_bf16 v58, v18, v34
v_dot2c_f32_bf16 v59, v19, v34
v_perm_b32 v16, v182, v178, s8
v_perm_b32 v17, v182, v178, s9
v_dot2c_f32_bf16 v60, v16, v34
v_dot2c_f32_bf16 v61, v17, v34
v_perm_b32 v18, v183, v179, s8
v_perm_b32 v19, v183, v179, s9
v_dot2c_f32_bf16 v62, v18, v34
v_dot2c_f32_bf16 v63, v19, v34
buffer_load_dwordx4 v[144:147], v11, s[44:47], s63 offen nt
buffer_load_dwordx4 v[176:179], v11, s[56:59], s63 offen nt
s_add_u32 s63, s63, 3584
buffer_load_dwordx4 v[148:151], v11, s[44:47], s63 offen nt
buffer_load_dwordx4 v[180:183], v11, s[56:59], s63 offen nt
s_add_u32 s63, s63, 3584
s_waitcnt vmcnt(30)
v_perm_b32 v16, v156, v152, s8
v_perm_b32 v17, v156, v152, s9
v_dot2c_f32_bf16 v24, v16, v35
v_dot2c_f32_bf16 v25, v17, v35
v_perm_b32 v18, v157, v153, s8
v_perm_b32 v19, v157, v153, s9
v_dot2c_f32_bf16 v26, v18, v35
v_dot2c_f32_bf16 v27, v19, v35
v_perm_b32 v16, v158, v154, s8
v_perm_b32 v17, v158, v154, s9
v_dot2c_f32_bf16 v28, v16, v35
v_dot2c_f32_bf16 v29, v17, v35
v_perm_b32 v18, v159, v155, s8
v_perm_b32 v19, v159, v155, s9
v_dot2c_f32_bf16 v30, v18, v35
v_dot2c_f32_bf16 v31, v19, v35
v_perm_b32 v16, v188, v184, s8
v_perm_b32 v17, v188, v184, s9
v_dot2c_f32_bf16 v56, v16, v35
v_dot2c_f32_bf16 v57, v17, v35
v_perm_b32 v18, v189, v185, s8
v_perm_b32 v19, v189, v185, s9
v_dot2c_f32_bf16 v58, v18, v35
v_dot2c_f32_bf16 v59, v19, v35
v_perm_b32 v16, v190, v186, s8
v_perm_b32 v17, v190, v186, s9
v_dot2c_f32_bf16 v60, v16, v35
v_dot2c_f32_bf16 v61, v17, v35
v_perm_b32 v18, v191, v187, s8
v_perm_b32 v19, v191, v187, s9
v_dot2c_f32_bf16 v62, v18, v35
v_dot2c_f32_bf16 v63, v19, v35
buffer_load_dwordx4 v[152:155], v11, s[44:47], s63 offen nt
buffer_load_dwordx4 v[184:187], v11, s[56:59], s63 offen nt
s_add_u32 s63, s63, 3584
buffer_load_dwordx4 v[156:159], v11, s[44:47], s63 offen nt
buffer_load_dwordx4 v[188:191], v11, s[56:59], s63 offen nt
s_add_u32 s63, s63, 3584
s_add_u32 s63, s63, 200704
s_add_u32 s62, s62, 1
s_branch .Lffnloop
.Lffndone:
s_waitcnt vmcnt(0)
s_mul_i32 s63, s78, 57344
buffer_load_dwordx4 v[64:67], v8, s[64:67], s63 offen nt
s_add_u32 s63, s63, 896
buffer_load_dwordx4 v[68:71], v8, s[64:67], s63 offen nt
s_add_u32 s63, s63, 896
buffer_load_dwordx4 v[72:75], v8, s[64:67], s63 offen nt
s_add_u32 s63, s63, 896
buffer_load_dwordx4 v[76:79], v8, s[64:67], s63 offen nt
s_add_u32 s63, s63, 896
buffer_load_dwordx4 v[80:83], v8, s[64:67], s63 offen nt
s_add_u32 s63, s63, 896
buffer_load_dwordx4 v[84:87], v8, s[64:67], s63 offen nt
s_add_u32 s63, s63, 896
buffer_load_dwordx4 v[88:91], v8, s[64:67], s63 offen nt
s_add_u32 s63, s63, 896
buffer_load_dwordx4 v[92:95], v8, s[64:67], s63 offen nt
s_add_u32 s63, s63, 896
buffer_load_dwordx4 v[96:99], v8, s[64:67], s63 offen nt
s_add_u32 s63, s63, 896
buffer_load_dwordx4 v[100:103], v8, s[64:67], s63 offen nt
s_add_u32 s63, s63, 896
buffer_load_dwordx4 v[104:107], v8, s[64:67], s63 offen nt
s_add_u32 s63, s63, 896
buffer_load_dwordx4 v[108:111], v8, s[64:67], s63 offen nt
s_add_u32 s63, s63, 896
buffer_load_dwordx4 v[112:115], v8, s[64:67], s63 offen nt
s_add_u32 s63, s63, 896
buffer_load_dwordx4 v[116:119], v8, s[64:67], s63 offen nt
s_add_u32 s63, s63, 896
buffer_load_dwordx4 v[120:123], v8, s[64:67], s63 offen nt
s_add_u32 s63, s63, 896
buffer_load_dwordx4 v[124:127], v8, s[64:67], s63 offen nt
s_add_u32 s63, s63, 896
buffer_load_dwordx4 v[128:131], v8, s[64:67], s63 offen nt
s_add_u32 s63, s63, 896
buffer_load_dwordx4 v[132:135], v8, s[64:67], s63 offen nt
s_add_u32 s63, s63, 896
buffer_load_dwordx4 v[136:139], v8, s[64:67], s63 offen nt
s_add_u32 s63, s63, 896
buffer_load_dwordx4 v[140:143], v8, s[64:67], s63 offen nt
s_add_u32 s63, s63, 896
buffer_load_dwordx4 v[144:147], v8, s[64:67], s63 offen nt
s_add_u32 s63, s63, 896
buffer_load_dwordx4 v[148:151], v8, s[64:67], s63 offen nt
s_add_u32 s63, s63, 896
buffer_load_dwordx4 v[152:155], v8, s[64:67], s63 offen nt
s_add_u32 s63, s63, 896
buffer_load_dwordx4 v[156:159], v8, s[64:67], s63 offen nt
s_add_u32 s63, s63, 896
buffer_load_dwordx4 v[160:163], v8, s[64:67], s63 offen nt
s_add_u32 s63, s63, 896
buffer_load_dwordx4 v[164:167], v8, s[64:67], s63 offen nt
s_add_u32 s63, s63, 896
buffer_load_dwordx4 v[168:171], v8, s[64:67], s63 offen nt
s_add_u32 s63, s63, 896
buffer_load_dwordx4 v[172:175], v8, s[64:67], s63 offen nt
s_add_u32 s63, s63, 896
buffer_load_dwordx4 v[176:179], v8, s[64:67], s63 offen nt
s_add_u32 s63, s63, 896
buffer_load_dwordx4 v[180:183], v8, s[64:67], s63 offen nt
s_add_u32 s63, s63, 896
buffer_load_dwordx4 v[184:187], v8, s[64:67], s63 offen nt
s_add_u32 s63, s63, 896
buffer_load_dwordx4 v[188:191], v8, s[64:67], s63 offen nt
s_add_u32 s63, s63, 896
s_branch .Lgather
.Lnoffn1:
.Lgather:
s_lshl_b32 s69, s4, 12
s_add_u32 s69, s69, 786432
s_mov_b32 s79, 0xffff
s_mov_b32 s71, 0
.Lpollq:
s_add_u32 s68, s69, 0
s_bitcmp1_b32 s79, 0
s_cbranch_scc0 .Lgq31
buffer_load_dwordx4 v[192:195], v8, s[48:51], s68 offen offset:0 sc1
.Lgq31:
s_bitcmp1_b32 s79, 1
s_cbranch_scc0 .Lgq32
buffer_load_dwordx4 v[196:199], v8, s[48:51], s68 offen offset:1024 sc1
.Lgq32:
s_bitcmp1_b32 s79, 2
s_cbranch_scc0 .Lgq33
buffer_load_dwordx4 v[200:203], v8, s[48:51], s68 offen offset:2048 sc1
.Lgq33:
s_bitcmp1_b32 s79, 3
s_cbranch_scc0 .Lgq34
buffer_load_dwordx4 v[204:207], v8, s[48:51], s68 offen offset:3072 sc1
.Lgq34:
s_add_u32 s68, s69, 32768
s_bitcmp1_b32 s79, 4
s_cbranch_scc0 .Lgq35
buffer_load_dwordx4 v[208:211], v8, s[48:51], s68 offen offset:0 sc1
.Lgq35:
s_bitcmp1_b32 s79, 5
s_cbranch_scc0 .Lgq36
buffer_load_dwordx4 v[212:215], v8, s[48:51], s68 offen offset:1024 sc1
.Lgq36:
s_bitcmp1_b32 s79, 6
s_cbranch_scc0 .Lgq37
buffer_load_dwordx4 v[216:219], v8, s[48:51], s68 offen offset:2048 sc1
.Lgq37:
s_bitcmp1_b32 s79, 7
s_cbranch_scc0 .Lgq38
buffer_load_dwordx4 v[220:223], v8, s[48:51], s68 offen offset:3072 sc1
.Lgq38:
s_add_u32 s68, s69, 65536
s_bitcmp1_b32 s79, 8
s_cbranch_scc0 .Lgq39
buffer_load_dwordx4 v[224:227], v8, s[48:51], s68 offen offset:0 sc1
.Lgq39:
s_bitcmp1_b32 s79, 9
s_cbranch_scc0 .Lgq40
buffer_load_dwordx4 v[228:231], v8, s[48:51], s68 offen offset:1024 sc1
.Lgq40:
s_bitcmp1_b32 s79, 10
s_cbranch_scc0 .Lgq41
buffer_load_dwordx4 v[232:235], v8, s[48:51], s68 offen offset:2048 sc1
.Lgq41:
s_bitcmp1_b32 s79, 11
s_cbranch_scc0 .Lgq42
buffer_load_dwordx4 v[236:239], v8, s[48:51], s68 offen offset:3072 sc1
.Lgq42:
s_add_u32 s68, s69, 98304
s_bitcmp1_b32 s79, 12
s_cbranch_scc0 .Lgq43
buffer_load_dwordx4 v[240:243], v8, s[48:51], s68 offen offset:0 sc1
.Lgq43:
s_bitcmp1_b32 s79, 13
s_cbranch_scc0 .Lgq44
buffer_load_dwordx4 v[244:247], v8, s[48:51], s68 offen offset:1024 sc1
.Lgq44:
s_bitcmp1_b32 s79, 14
s_cbranch_scc0 .Lgq45
buffer_load_dwordx4 v[248:251], v8, s[48:51], s68 offen offset:2048 sc1
.Lgq45:
s_bitcmp1_b32 s79, 15
s_cbranch_scc0 .Lgq46
buffer_load_dwordx4 v[252:255], v8, s[48:51], s68 offen offset:3072 sc1
.Lgq46:
s_waitcnt vmcnt(0)
v_cmp_ne_u32 vcc, s72, v193
v_cmp_ne_u32 s[74:75], s72, v195
s_or_b64 s[74:75], vcc, s[74:75]
s_cselect_b32 s76, -1, 0xfffffffe
s_and_b32 s79, s79, s76
v_cmp_ne_u32 vcc, s72, v197
v_cmp_ne_u32 s[74:75], s72, v199
s_or_b64 s[74:75], vcc, s[74:75]
s_cselect_b32 s76, -1, 0xfffffffd
s_and_b32 s79, s79, s76
v_cmp_ne_u32 vcc, s72, v201
v_cmp_ne_u32 s[74:75], s72, v203
s_or_b64 s[74:75], vcc, s[74:75]
s_cselect_b32 s76, -1, 0xfffffffb
s_and_b32 s79, s79, s76
v_cmp_ne_u32 vcc, s72, v205
v_cmp_ne_u32 s[74:75], s72, v207
s_or_b64 s[74:75], vcc, s[74:75]
s_cselect_b32 s76, -1, 0xfffffff7
s_and_b32 s79, s79, s76
v_cmp_ne_u32 vcc, s72, v209
v_cmp_ne_u32 s[74:75], s72, v211
s_or_b64 s[74:75], vcc, s[74:75]
s_cselect_b32 s76, -1, 0xffffffef
s_and_b32 s79, s79, s76
v_cmp_ne_u32 vcc, s72, v213
v_cmp_ne_u32 s[74:75], s72, v215
s_or_b64 s[74:75], vcc, s[74:75]
s_cselect_b32 s76, -1, 0xffffffdf
s_and_b32 s79, s79, s76
v_cmp_ne_u32 vcc, s72, v217
v_cmp_ne_u32 s[74:75], s72, v219
s_or_b64 s[74:75], vcc, s[74:75]
s_cselect_b32 s76, -1, 0xffffffbf
s_and_b32 s79, s79, s76
v_cmp_ne_u32 vcc, s72, v221
v_cmp_ne_u32 s[74:75], s72, v223
s_or_b64 s[74:75], vcc, s[74:75]
s_cselect_b32 s76, -1, 0xffffff7f
s_and_b32 s79, s79, s76
v_cmp_ne_u32 vcc, s72, v225
v_cmp_ne_u32 s[74:75], s72, v227
s_or_b64 s[74:75], vcc, s[74:75]
s_cselect_b32 s76, -1, 0xfffffeff
s_and_b32 s79, s79, s76
v_cmp_ne_u32 vcc, s72, v229
v_cmp_ne_u32 s[74:75], s72, v231
s_or_b64 s[74:75], vcc, s[74:75]
s_cselect_b32 s76, -1, 0xfffffdff
s_and_b32 s79, s79, s76
v_cmp_ne_u32 vcc, s72, v233
v_cmp_ne_u32 s[74:75], s72, v235
s_or_b64 s[74:75], vcc, s[74:75]
s_cselect_b32 s76, -1, 0xfffffbff
s_and_b32 s79, s79, s76
v_cmp_ne_u32 vcc, s72, v237
v_cmp_ne_u32 s[74:75], s72, v239
s_or_b64 s[74:75], vcc, s[74:75]
s_cselect_b32 s76, -1, 0xfffff7ff
s_and_b32 s79, s79, s76
v_cmp_ne_u32 vcc, s72, v241
v_cmp_ne_u32 s[74:75], s72, v243
s_or_b64 s[74:75], vcc, s[74:75]
s_cselect_b32 s76, -1, 0xffffefff
s_and_b32 s79, s79, s76
v_cmp_ne_u32 vcc, s72, v245
v_cmp_ne_u32 s[74:75], s72, v247
s_or_b64 s[74:75], vcc, s[74:75]
s_cselect_b32 s76, -1, 0xffffdfff
s_and_b32 s79, s79, s76
v_cmp_ne_u32 vcc, s72, v249
v_cmp_ne_u32 s[74:75], s72, v251
s_or_b64 s[74:75], vcc, s[74:75]
s_cselect_b32 s76, -1, 0xffffbfff
s_and_b32 s79, s79, s76
v_cmp_ne_u32 vcc, s72, v253
v_cmp_ne_u32 s[74:75], s72, v255
s_or_b64 s[74:75], vcc, s[74:75]
s_cselect_b32 s76, -1, 0xffff7fff
s_and_b32 s79, s79, s76
s_add_u32 s71, s71, 1
s_cmp_eq_u32 s79, 0
s_cbranch_scc1 .Lpollq_done
s_cmp_lt_u32 s71, 100000
s_cbranch_scc1 .Lpollq
.Lpollq_done:
v_add_f32 v192, v192, v208
v_add_f32 v194, v194, v210
v_add_f32 v192, v192, v224
v_add_f32 v194, v194, v226
v_add_f32 v192, v192, v240
v_add_f32 v194, v194, v242
v_cvt_pk_bf16_f32 v16, v192, v194
ds_write_b32 v10, v16 offset:0
v_add_f32 v196, v196, v212
v_add_f32 v198, v198, v214
v_add_f32 v196, v196, v228
v_add_f32 v198, v198, v230
v_add_f32 v196, v196, v244
v_add_f32 v198, v198, v246
v_cvt_pk_bf16_f32 v17, v196, v198
ds_write_b32 v10, v17 offset:256
v_add_f32 v200, v200, v216
v_add_f32 v202, v202, v218
v_add_f32 v200, v200, v232
v_add_f32 v202, v202, v234
v_add_f32 v200, v200, v248
v_add_f32 v202, v202, v250
v_cvt_pk_bf16_f32 v18, v200, v202
ds_write_b32 v10, v18 offset:512
v_add_f32 v204, v204, v220
v_add_f32 v206, v206, v222
v_add_f32 v204, v204, v236
v_add_f32 v206, v206, v238
v_add_f32 v204, v204, v252
v_add_f32 v206, v206, v254
v_cvt_pk_bf16_f32 v19, v204, v206
ds_write_b32 v10, v19 offset:768
s_waitcnt lgkmcnt(0)
s_cmp_lg_u32 s73, 1
s_cselect_b32 s74, 1, 0
v_mov_b32 v16, s74
ds_write_b32 v9, v16 offset:1416
s_cmp_eq_u32 s73, 1
s_cbranch_scc1 .Llazy_done
s_mov_b32 s71, 0
.Llazy:
ds_read_b32 v16, v9 offset:1408
s_waitcnt lgkmcnt(0)
v_readfirstlane_b32 s68, v16
s_add_u32 s71, s71, 1
s_cmp_ge_u32 s68, 30
s_cbranch_scc1 .Llazy_done
s_sleep 16
s_cmp_lt_u32 s71, 100000
s_cbranch_scc1 .Llazy
.Llazy_done:
s_mov_b32 s68, 253952
s_mov_b32 s71, 0
s_branch .Lpollc1
.Lpollc:
s_sleep 100
.Lpollc1:
buffer_load_dwordx4 v[16:19], v8, s[48:51], s68 offen sc1
s_waitcnt vmcnt(0)
v_xor_b32 v16, s72, v16
v_xor_b32 v17, s72, v17
v_xor_b32 v18, s72, v18
v_xor_b32 v19, s72, v19
v_or3_b32 v16, v16, v17, v18
v_or_b32 v16, v16, v19
v_cmp_ne_u32 vcc, 0, v16
s_add_u32 s71, s71, 1
s_cbranch_vccz .Lpollc_done
s_cmp_lt_u32 s71, 100000
s_cbranch_scc1 .Lpollc
.Lpollc_done:
v_mov_b32 v16, 1
ds_write_b32 v9, v16 offset:1412
s_cmp_lg_u32 s73, 1
s_cbranch_scc1 .Lnoffn
s_mov_b32 s64, s32
s_mov_b32 s65, s33
s_mov_b32 s66, 0x188000
s_mov_b32 s67, 0x20000
v_permlane32_swap_b32 v24, v28
v_permlane32_swap_b32 v25, v29
v_permlane32_swap_b32 v26, v30
v_permlane32_swap_b32 v27, v31
s_nop 1
v_add_f32 v24, v24, v28
v_add_f32 v25, v25, v29
v_add_f32 v26, v26, v30
v_add_f32 v27, v27, v31
s_nop 0
v_permlane16_swap_b32 v24, v26
v_permlane16_swap_b32 v25, v27
s_nop 1
v_add_f32 v24, v24, v26
v_add_f32 v25, v25, v27
s_nop 0
v_add_f32_dpp v26, v24, v24 row_ror:8 row_mask:0xf bank_mask:0x3
v_add_f32_dpp v26, v25, v25 row_ror:8 row_mask:0xf bank_mask:0xc
v_permlane32_swap_b32 v56, v60
v_permlane32_swap_b32 v57, v61
v_permlane32_swap_b32 v58, v62
v_permlane32_swap_b32 v59, v63
s_nop 1
v_add_f32 v56, v56, v60
v_add_f32 v57, v57, v61
v_add_f32 v58, v58, v62
v_add_f32 v59, v59, v63
s_nop 0
v_permlane16_swap_b32 v56, v58
v_permlane16_swap_b32 v57, v59
s_nop 1
v_add_f32 v56, v56, v58
v_add_f32 v57, v57, v59
s_nop 0
v_add_f32_dpp v58, v56, v56 row_ror:8 row_mask:0xf bank_mask:0x3
v_add_f32_dpp v58, v57, v57 row_ror:8 row_mask:0xf bank_mask:0xc
v_cvt_pk_bf16_f32 v18, v26, v58
v_lshlrev_b32 v16, 16, v18
v_and_b32 v17, 0xffff0000, v18
v_mul_f32 v18, 0xbfb8aa3b, v16
v_exp_f32 v18, v18
s_nop 0
v_add_f32 v18, 1.0, v18
v_rcp_f32 v18, v18
s_nop 0
v_mul_f32 v18, v16, v18
v_cvt_pk_bf16_f32 v18, v18, v18
v_lshlrev_b32 v18, 16, v18
v_mul_f32 v18, v18, v17
s_nop 1
v_mov_b32_dpp v19, v18 row_ror:8 row_mask:0xf bank_mask:0xf
v_cvt_pk_bf16_f32 v50, v18, v19
v_mov_b32 v24, 0
v_mov_b32 v25, 0
v_mov_b32 v26, 0
v_mov_b32 v27, 0
v_mov_b32 v28, 0
v_mov_b32 v29, 0
v_mov_b32 v30, 0
v_mov_b32 v31, 0
s_mov_b32 s62, 0
.Lwdloop:
s_add_u32 s61, s62, 0
v_readlane_b32 s80, v50, s61
s_waitcnt vmcnt(30)
v_perm_b32 v16, v68, v64, s8
v_perm_b32 v17, v68, v64, s9
v_dot2c_f32_bf16 v24, s80, v16
v_dot2c_f32_bf16 v25, s80, v17
v_perm_b32 v18, v69, v65, s8
v_perm_b32 v19, v69, v65, s9
v_dot2c_f32_bf16 v26, s80, v18
v_dot2c_f32_bf16 v27, s80, v19
v_perm_b32 v16, v70, v66, s8
v_perm_b32 v17, v70, v66, s9
v_dot2c_f32_bf16 v28, s80, v16
v_dot2c_f32_bf16 v29, s80, v17
v_perm_b32 v18, v71, v67, s8
v_perm_b32 v19, v71, v67, s9
v_dot2c_f32_bf16 v30, s80, v18
v_dot2c_f32_bf16 v31, s80, v19
buffer_load_dwordx4 v[64:67], v8, s[64:67], s63 offen nt
s_add_u32 s63, s63, 896
buffer_load_dwordx4 v[68:71], v8, s[64:67], s63 offen nt
s_add_u32 s63, s63, 896
s_add_u32 s61, s62, 16
v_readlane_b32 s80, v50, s61
s_waitcnt vmcnt(30)
v_perm_b32 v16, v76, v72, s8
v_perm_b32 v17, v76, v72, s9
v_dot2c_f32_bf16 v24, s80, v16
v_dot2c_f32_bf16 v25, s80, v17
v_perm_b32 v18, v77, v73, s8
v_perm_b32 v19, v77, v73, s9
v_dot2c_f32_bf16 v26, s80, v18
v_dot2c_f32_bf16 v27, s80, v19
v_perm_b32 v16, v78, v74, s8
v_perm_b32 v17, v78, v74, s9
v_dot2c_f32_bf16 v28, s80, v16
v_dot2c_f32_bf16 v29, s80, v17
v_perm_b32 v18, v79, v75, s8
v_perm_b32 v19, v79, v75, s9
v_dot2c_f32_bf16 v30, s80, v18
v_dot2c_f32_bf16 v31, s80, v19
buffer_load_dwordx4 v[72:75], v8, s[64:67], s63 offen nt
s_add_u32 s63, s63, 896
buffer_load_dwordx4 v[76:79], v8, s[64:67], s63 offen nt
s_add_u32 s63, s63, 896
s_add_u32 s61, s62, 32
v_readlane_b32 s80, v50, s61
s_waitcnt vmcnt(30)
v_perm_b32 v16, v84, v80, s8
v_perm_b32 v17, v84, v80, s9
v_dot2c_f32_bf16 v24, s80, v16
v_dot2c_f32_bf16 v25, s80, v17
v_perm_b32 v18, v85, v81, s8
v_perm_b32 v19, v85, v81, s9
v_dot2c_f32_bf16 v26, s80, v18
v_dot2c_f32_bf16 v27, s80, v19
v_perm_b32 v16, v86, v82, s8
v_perm_b32 v17, v86, v82, s9
v_dot2c_f32_bf16 v28, s80, v16
v_dot2c_f32_bf16 v29, s80, v17
v_perm_b32 v18, v87, v83, s8
v_perm_b32 v19, v87, v83, s9
v_dot2c_f32_bf16 v30, s80, v18
v_dot2c_f32_bf16 v31, s80, v19
buffer_load_dwordx4 v[80:83], v8, s[64:67], s63 offen nt
s_add_u32 s63, s63, 896
buffer_load_dwordx4 v[84:87], v8, s[64:67], s63 offen nt
s_add_u32 s63, s63, 896
s_add_u32 s61, s62, 48
v_readlane_b32 s80, v50, s61
s_waitcnt vmcnt(30)
v_perm_b32 v16, v92, v88, s8
v_perm_b32 v17, v92, v88, s9
v_dot2c_f32_bf16 v24, s80, v16
v_dot2c_f32_bf16 v25, s80, v17
v_perm_b32 v18, v93, v89, s8
v_perm_b32 v19, v93, v89, s9
v_dot2c_f32_bf16 v26, s80, v18
v_dot2c_f32_bf16 v27, s80, v19
v_perm_b32 v16, v94, v90, s8
v_perm_b32 v17, v94, v90, s9
v_dot2c_f32_bf16 v28, s80, v16
v_dot2c_f32_bf16 v29, s80, v17
v_perm_b32 v18, v95, v91, s8
v_perm_b32 v19, v95, v91, s9
v_dot2c_f32_bf16 v30, s80, v18
v_dot2c_f32_bf16 v31, s80, v19
buffer_load_dwordx4 v[88:91], v8, s[64:67], s63 offen nt
s_add_u32 s63, s63, 896
buffer_load_dwordx4 v[92:95], v8, s[64:67], s63 offen nt
s_add_u32 s63, s63, 896
s_add_u32 s61, s62, 1
v_readlane_b32 s80, v50, s61
s_waitcnt vmcnt(30)
v_perm_b32 v16, v100, v96, s8
v_perm_b32 v17, v100, v96, s9
v_dot2c_f32_bf16 v24, s80, v16
v_dot2c_f32_bf16 v25, s80, v17
v_perm_b32 v18, v101, v97, s8
v_perm_b32 v19, v101, v97, s9
v_dot2c_f32_bf16 v26, s80, v18
v_dot2c_f32_bf16 v27, s80, v19
v_perm_b32 v16, v102, v98, s8
v_perm_b32 v17, v102, v98, s9
v_dot2c_f32_bf16 v28, s80, v16
v_dot2c_f32_bf16 v29, s80, v17
v_perm_b32 v18, v103, v99, s8
v_perm_b32 v19, v103, v99, s9
v_dot2c_f32_bf16 v30, s80, v18
v_dot2c_f32_bf16 v31, s80, v19
buffer_load_dwordx4 v[96:99], v8, s[64:67], s63 offen nt
s_add_u32 s63, s63, 896
buffer_load_dwordx4 v[100:103], v8, s[64:67], s63 offen nt
s_add_u32 s63, s63, 896
s_add_u32 s61, s62, 17
v_readlane_b32 s80, v50, s61
s_waitcnt vmcnt(30)
v_perm_b32 v16, v108, v104, s8
v_perm_b32 v17, v108, v104, s9
v_dot2c_f32_bf16 v24, s80, v16
v_dot2c_f32_bf16 v25, s80, v17
v_perm_b32 v18, v109, v105, s8
v_perm_b32 v19, v109, v105, s9
v_dot2c_f32_bf16 v26, s80, v18
v_dot2c_f32_bf16 v27, s80, v19
v_perm_b32 v16, v110, v106, s8
v_perm_b32 v17, v110, v106, s9
v_dot2c_f32_bf16 v28, s80, v16
v_dot2c_f32_bf16 v29, s80, v17
v_perm_b32 v18, v111, v107, s8
v_perm_b32 v19, v111, v107, s9
v_dot2c_f32_bf16 v30, s80, v18
v_dot2c_f32_bf16 v31, s80, v19
buffer_load_dwordx4 v[104:107], v8, s[64:67], s63 offen nt
s_add_u32 s63, s63, 896
buffer_load_dwordx4 v[108:111], v8, s[64:67], s63 offen nt
s_add_u32 s63, s63, 896
s_add_u32 s61, s62, 33
v_readlane_b32 s80, v50, s61
s_waitcnt vmcnt(30)
v_perm_b32 v16, v116, v112, s8
v_perm_b32 v17, v116, v112, s9
v_dot2c_f32_bf16 v24, s80, v16
v_dot2c_f32_bf16 v25, s80, v17
v_perm_b32 v18, v117, v113, s8
v_perm_b32 v19, v117, v113, s9
v_dot2c_f32_bf16 v26, s80, v18
v_dot2c_f32_bf16 v27, s80, v19
v_perm_b32 v16, v118, v114, s8
v_perm_b32 v17, v118, v114, s9
v_dot2c_f32_bf16 v28, s80, v16
v_dot2c_f32_bf16 v29, s80, v17
v_perm_b32 v18, v119, v115, s8
v_perm_b32 v19, v119, v115, s9
v_dot2c_f32_bf16 v30, s80, v18
v_dot2c_f32_bf16 v31, s80, v19
buffer_load_dwordx4 v[112:115], v8, s[64:67], s63 offen nt
s_add_u32 s63, s63, 896
buffer_load_dwordx4 v[116:119], v8, s[64:67], s63 offen nt
s_add_u32 s63, s63, 896
s_add_u32 s61, s62, 49
v_readlane_b32 s80, v50, s61
s_waitcnt vmcnt(30)
v_perm_b32 v16, v124, v120, s8
v_perm_b32 v17, v124, v120, s9
v_dot2c_f32_bf16 v24, s80, v16
v_dot2c_f32_bf16 v25, s80, v17
v_perm_b32 v18, v125, v121, s8
v_perm_b32 v19, v125, v121, s9
v_dot2c_f32_bf16 v26, s80, v18
v_dot2c_f32_bf16 v27, s80, v19
v_perm_b32 v16, v126, v122, s8
v_perm_b32 v17, v126, v122, s9
v_dot2c_f32_bf16 v28, s80, v16
v_dot2c_f32_bf16 v29, s80, v17
v_perm_b32 v18, v127, v123, s8
v_perm_b32 v19, v127, v123, s9
v_dot2c_f32_bf16 v30, s80, v18
v_dot2c_f32_bf16 v31, s80, v19
buffer_load_dwordx4 v[120:123], v8, s[64:67], s63 offen nt
s_add_u32 s63, s63, 896
buffer_load_dwordx4 v[124:127], v8, s[64:67], s63 offen nt
s_add_u32 s63, s63, 896
s_add_u32 s61, s62, 2
v_readlane_b32 s80, v50, s61
s_waitcnt vmcnt(30)
v_perm_b32 v16, v132, v128, s8
v_perm_b32 v17, v132, v128, s9
v_dot2c_f32_bf16 v24, s80, v16
v_dot2c_f32_bf16 v25, s80, v17
v_perm_b32 v18, v133, v129, s8
v_perm_b32 v19, v133, v129, s9
v_dot2c_f32_bf16 v26, s80, v18
v_dot2c_f32_bf16 v27, s80, v19
v_perm_b32 v16, v134, v130, s8
v_perm_b32 v17, v134, v130, s9
v_dot2c_f32_bf16 v28, s80, v16
v_dot2c_f32_bf16 v29, s80, v17
v_perm_b32 v18, v135, v131, s8
v_perm_b32 v19, v135, v131, s9
v_dot2c_f32_bf16 v30, s80, v18
v_dot2c_f32_bf16 v31, s80, v19
buffer_load_dwordx4 v[128:131], v8, s[64:67], s63 offen nt
s_add_u32 s63, s63, 896
buffer_load_dwordx4 v[132:135], v8, s[64:67], s63 offen nt
s_add_u32 s63, s63, 896
s_add_u32 s61, s62, 18
v_readlane_b32 s80, v50, s61
s_waitcnt vmcnt(30)
v_perm_b32 v16, v140, v136, s8
v_perm_b32 v17, v140, v136, s9
v_dot2c_f32_bf16 v24, s80, v16
v_dot2c_f32_bf16 v25, s80, v17
v_perm_b32 v18, v141, v137, s8
v_perm_b32 v19, v141, v137, s9
v_dot2c_f32_bf16 v26, s80, v18
v_dot2c_f32_bf16 v27, s80, v19
v_perm_b32 v16, v142, v138, s8
v_perm_b32 v17, v142, v138, s9
v_dot2c_f32_bf16 v28, s80, v16
v_dot2c_f32_bf16 v29, s80, v17
v_perm_b32 v18, v143, v139, s8
v_perm_b32 v19, v143, v139, s9
v_dot2c_f32_bf16 v30, s80, v18
v_dot2c_f32_bf16 v31, s80, v19
buffer_load_dwordx4 v[136:139], v8, s[64:67], s63 offen nt
s_add_u32 s63, s63, 896
buffer_load_dwordx4 v[140:143], v8, s[64:67], s63 offen nt
s_add_u32 s63, s63, 896
s_add_u32 s61, s62, 34
v_readlane_b32 s80, v50, s61
s_waitcnt vmcnt(30)
v_perm_b32 v16, v148, v144, s8
v_perm_b32 v17, v148, v144, s9
v_dot2c_f32_bf16 v24, s80, v16
v_dot2c_f32_bf16 v25, s80, v17
v_perm_b32 v18, v149, v145, s8
v_perm_b32 v19, v149, v145, s9
v_dot2c_f32_bf16 v26, s80, v18
v_dot2c_f32_bf16 v27, s80, v19
v_perm_b32 v16, v150, v146, s8
v_perm_b32 v17, v150, v146, s9
v_dot2c_f32_bf16 v28, s80, v16
v_dot2c_f32_bf16 v29, s80, v17
v_perm_b32 v18, v151, v147, s8
v_perm_b32 v19, v151, v147, s9
v_dot2c_f32_bf16 v30, s80, v18
v_dot2c_f32_bf16 v31, s80, v19
buffer_load_dwordx4 v[144:147], v8, s[64:67], s63 offen nt
s_add_u32 s63, s63, 896
buffer_load_dwordx4 v[148:151], v8, s[64:67], s63 offen nt
s_add_u32 s63, s63, 896
s_add_u32 s61, s62, 50
v_readlane_b32 s80, v50, s61
s_waitcnt vmcnt(30)
v_perm_b32 v16, v156, v152, s8
v_perm_b32 v17, v156, v152, s9
v_dot2c_f32_bf16 v24, s80, v16
v_dot2c_f32_bf16 v25, s80, v17
v_perm_b32 v18, v157, v153, s8
v_perm_b32 v19, v157, v153, s9
v_dot2c_f32_bf16 v26, s80, v18
v_dot2c_f32_bf16 v27, s80, v19
v_perm_b32 v16, v158, v154, s8
v_perm_b32 v17, v158, v154, s9
v_dot2c_f32_bf16 v28, s80, v16
v_dot2c_f32_bf16 v29, s80, v17
v_perm_b32 v18, v159, v155, s8
v_perm_b32 v19, v159, v155, s9
v_dot2c_f32_bf16 v30, s80, v18
v_dot2c_f32_bf16 v31, s80, v19
buffer_load_dwordx4 v[152:155], v8, s[64:67], s63 offen nt
s_add_u32 s63, s63, 896
buffer_load_dwordx4 v[156:159], v8, s[64:67], s63 offen nt
s_add_u32 s63, s63, 896
s_add_u32 s61, s62, 3
v_readlane_b32 s80, v50, s61
s_waitcnt vmcnt(30)
v_perm_b32 v16, v164, v160, s8
v_perm_b32 v17, v164, v160, s9
v_dot2c_f32_bf16 v24, s80, v16
v_dot2c_f32_bf16 v25, s80, v17
v_perm_b32 v18, v165, v161, s8
v_perm_b32 v19, v165, v161, s9
v_dot2c_f32_bf16 v26, s80, v18
v_dot2c_f32_bf16 v27, s80, v19
v_perm_b32 v16, v166, v162, s8
v_perm_b32 v17, v166, v162, s9
v_dot2c_f32_bf16 v28, s80, v16
v_dot2c_f32_bf16 v29, s80, v17
v_perm_b32 v18, v167, v163, s8
v_perm_b32 v19, v167, v163, s9
v_dot2c_f32_bf16 v30, s80, v18
v_dot2c_f32_bf16 v31, s80, v19
buffer_load_dwordx4 v[160:163], v8, s[64:67], s63 offen nt
s_add_u32 s63, s63, 896
buffer_load_dwordx4 v[164:167], v8, s[64:67], s63 offen nt
s_add_u32 s63, s63, 896
s_add_u32 s61, s62, 19
v_readlane_b32 s80, v50, s61
s_waitcnt vmcnt(30)
v_perm_b32 v16, v172, v168, s8
v_perm_b32 v17, v172, v168, s9
v_dot2c_f32_bf16 v24, s80, v16
v_dot2c_f32_bf16 v25, s80, v17
v_perm_b32 v18, v173, v169, s8
v_perm_b32 v19, v173, v169, s9
v_dot2c_f32_bf16 v26, s80, v18
v_dot2c_f32_bf16 v27, s80, v19
v_perm_b32 v16, v174, v170, s8
v_perm_b32 v17, v174, v170, s9
v_dot2c_f32_bf16 v28, s80, v16
v_dot2c_f32_bf16 v29, s80, v17
v_perm_b32 v18, v175, v171, s8
v_perm_b32 v19, v175, v171, s9
v_dot2c_f32_bf16 v30, s80, v18
v_dot2c_f32_bf16 v31, s80, v19
buffer_load_dwordx4 v[168:171], v8, s[64:67], s63 offen nt
s_add_u32 s63, s63, 896
buffer_load_dwordx4 v[172:175], v8, s[64:67], s63 offen nt
s_add_u32 s63, s63, 896
s_add_u32 s61, s62, 35
v_readlane_b32 s80, v50, s61
s_waitcnt vmcnt(30)
v_perm_b32 v16, v180, v176, s8
v_perm_b32 v17, v180, v176, s9
v_dot2c_f32_bf16 v24, s80, v16
v_dot2c_f32_bf16 v25, s80, v17
v_perm_b32 v18, v181, v177, s8
v_perm_b32 v19, v181, v177, s9
v_dot2c_f32_bf16 v26, s80, v18
v_dot2c_f32_bf16 v27, s80, v19
v_perm_b32 v16, v182, v178, s8
v_perm_b32 v17, v182, v178, s9
v_dot2c_f32_bf16 v28, s80, v16
v_dot2c_f32_bf16 v29, s80, v17
v_perm_b32 v18, v183, v179, s8
v_perm_b32 v19, v183, v179, s9
v_dot2c_f32_bf16 v30, s80, v18
v_dot2c_f32_bf16 v31, s80, v19
buffer_load_dwordx4 v[176:179], v8, s[64:67], s63 offen nt
s_add_u32 s63, s63, 896
buffer_load_dwordx4 v[180:183], v8, s[64:67], s63 offen nt
s_add_u32 s63, s63, 896
s_add_u32 s61, s62, 51
v_readlane_b32 s80, v50, s61
s_waitcnt vmcnt(30)
v_perm_b32 v16, v188, v184, s8
v_perm_b32 v17, v188, v184, s9
v_dot2c_f32_bf16 v24, s80, v16
v_dot2c_f32_bf16 v25, s80, v17
v_perm_b32 v18, v189, v185, s8
v_perm_b32 v19, v189, v185, s9
v_dot2c_f32_bf16 v26, s80, v18
v_dot2c_f32_bf16 v27, s80, v19
v_perm_b32 v16, v190, v186, s8
v_perm_b32 v17, v190, v186, s9
v_dot2c_f32_bf16 v28, s80, v16
v_dot2c_f32_bf16 v29, s80, v17
v_perm_b32 v18, v191, v187, s8
v_perm_b32 v19, v191, v187, s9
v_dot2c_f32_bf16 v30, s80, v18
v_dot2c_f32_bf16 v31, s80, v19
buffer_load_dwordx4 v[184:187], v8, s[64:67], s63 offen nt
s_add_u32 s63, s63, 896
buffer_load_dwordx4 v[188:191], v8, s[64:67], s63 offen nt
s_add_u32 s63, s63, 896
s_mov_b32 s63, 0x10000000
v_mov_b32 v20, 1
ds_write_b32 v9, v20 offset:1416
s_add_u32 s62, s62, 4
s_cmp_lt_u32 s62, 8
s_cbranch_scc1 .Lwdloop
v_lshrrev_b32 v11, 1, v0
v_lshlrev_b32 v11, 12, v11
v_and_b32 v12, 1, v0
v_lshl_add_u32 v11, v12, 6, v11
v_cmp_gt_u32 vcc, 56, v0
s_nop 1
v_cndmask_b32 v11, v51, v11, vcc
v_mov_b32 v192, v24
v_mov_b32 v193, s72
v_mov_b32 v194, v25
v_mov_b32 v195, s72
v_mov_b32 v196, v26
v_mov_b32 v197, s72
v_mov_b32 v198, v27
v_mov_b32 v199, s72
v_mov_b32 v200, v28
v_mov_b32 v201, s72
v_mov_b32 v202, v29
v_mov_b32 v203, s72
v_mov_b32 v204, v30
v_mov_b32 v205, s72
v_mov_b32 v206, v31
v_mov_b32 v207, s72
s_lshl_b32 s68, s78, 7
s_add_u32 s68, s68, 1703936
buffer_store_dwordx4 v[192:195], v11, s[48:51], s68 offen offset:0 sc1
buffer_store_dwordx4 v[196:199], v11, s[48:51], s68 offen offset:16 sc1
buffer_store_dwordx4 v[200:203], v11, s[48:51], s68 offen offset:32 sc1
buffer_store_dwordx4 v[204:207], v11, s[48:51], s68 offen offset:48 sc1
s_waitcnt vmcnt(0)
.Lnoffn:
s_cmp_lg_u32 s73, 2
s_cbranch_scc1 .Lnof3
v_lshlrev_b32 v16, 2, v3
s_lshl_b32 s68, s78, 5
buffer_load_dword v57, v16, s[40:43], s68 offen
s_lshl_b32 s68, s78, 12
s_add_u32 s68, s68, 1703936
v_cmp_gt_u32 s[62:63], 32, v0
v_and_b32 v58, 0x1ff, v8
s_mov_b32 s71, 0
.Lpollf:
s_sleep 64
buffer_load_dwordx4 v[64:67], v8, s[48:51], s68 offen offset:0 sc1
buffer_load_dwordx4 v[68:71], v8, s[48:51], s68 offen offset:1024 sc1
buffer_load_dwordx4 v[72:75], v8, s[48:51], s68 offen offset:2048 sc1
buffer_load_dwordx4 v[76:79], v58, s[48:51], s68 offen offset:3072 sc1
s_waitcnt vmcnt(0)
v_xor_b32 v16, s72, v65
v_xor_b32 v17, s72, v67
v_or_b32 v16, v16, v17
v_xor_b32 v17, s72, v69
v_or_b32 v16, v16, v17
v_xor_b32 v17, s72, v71
v_or_b32 v16, v16, v17
v_xor_b32 v17, s72, v73
v_or_b32 v16, v16, v17
v_xor_b32 v17, s72, v75
v_or_b32 v16, v16, v17
v_xor_b32 v17, s72, v77
v_or_b32 v16, v16, v17
v_xor_b32 v17, s72, v79
v_or_b32 v16, v16, v17
v_cmp_ne_u32 vcc, 0, v16
s_add_u32 s71, s71, 1
s_cbranch_vccz .Lpollf_done
s_cmp_lt_u32 s71, 100000
s_cbranch_scc1 .Lpollf
.Lpollf_done:
v_cndmask_b32 v20, 0, v76, s[62:63]
v_cndmask_b32 v21, 0, v78, s[62:63]
v_add_f32 v20, v20, v64
v_add_f32 v21, v21, v66
v_add_f32 v20, v20, v68
v_add_f32 v21, v21, v70
v_add_f32 v20, v20, v72
v_add_f32 v21, v21, v74
s_nop 0
v_add_f32_dpp v20, v20, v20 row_ror:8 row_mask:0xf bank_mask:0xf
v_add_f32_dpp v21, v21, v21 row_ror:8 row_mask:0xf bank_mask:0xf
v_mov_b32 v18, v20
v_mov_b32 v19, v21
s_nop 0
v_permlane16_swap_b32 v20, v18
v_permlane16_swap_b32 v21, v19
s_nop 1
v_add_f32 v20, v20, v18
v_add_f32 v21, v21, v19
v_mov_b32 v18, v20
v_mov_b32 v19, v21
s_nop 0
v_permlane32_swap_b32 v20, v18
v_permlane32_swap_b32 v21, v19
s_nop 1
v_add_f32 v20, v20, v18
v_add_f32 v21, v21, v19
v_cvt_pk_bf16_f32 v22, v20, v21
v_lshlrev_b32 v20, 16, v22
v_and_b32 v21, 0xffff0000, v22
v_lshlrev_b32 v22, 16, v57
v_and_b32 v23, 0xffff0000, v57
v_lshlrev_b32 v16, 3, v3
ds_write_b64 v16, v[20:21] offset:1280
ds_write_b64 v16, v[22:23] offset:1344
.Lnof3:
s_mov_b32 s56, s24
s_mov_b32 s57, s25
s_mov_b32 s58, 0x380000
s_mov_b32 s59, 0x20000
s_mul_i32 s60, s2, 14336
s_add_u32 s61, s60, 4096
s_add_u32 s62, s60, 8192
s_add_u32 s63, s60, 12288
v_lshlrev_b32 v11, 3, v0
v_lshlrev_b32 v60, 5, v0
v_and_b32 v63, 1, v0
v_mov_b32 v61, 0x42800000
v_lshrrev_b32 v62, 2, v0
v_mul_u32_u24 v62, 16384, v62
v_and_b32 v63, 3, v0
v_lshl_add_u32 v62, v63, 4, v62
v_add_u32 v63, 262144, v62
v_cmp_gt_u32 vcc, 48, v0
s_nop 1
v_cndmask_b32 v63, v51, v63, vcc
s_lshl_b32 s74, s2, 11
s_add_u32 s74, s74, 262144
s_lshl_b32 s76, s2, 6
s_add_u32 s76, s76, 1048576
s_waitcnt vmcnt(0) lgkmcnt(0)
s_mov_b32 s77, s76
.Lhbar2:
s_barrier
buffer_load_dwordx2 v[128:129], v11, s[56:59], s60 offen offset:0 nt
buffer_load_dwordx2 v[130:131], v11, s[56:59], s60 offen offset:512 nt
buffer_load_dwordx2 v[132:133], v11, s[56:59], s60 offen offset:896 nt
buffer_load_dwordx2 v[134:135], v11, s[56:59], s60 offen offset:1408 nt
buffer_load_dwordx2 v[136:137], v11, s[56:59], s60 offen offset:1792 nt
buffer_load_dwordx2 v[138:139], v11, s[56:59], s60 offen offset:2304 nt
buffer_load_dwordx2 v[140:141], v11, s[56:59], s60 offen offset:2688 nt
buffer_load_dwordx2 v[142:143], v11, s[56:59], s60 offen offset:3200 nt
buffer_load_dwordx2 v[144:145], v11, s[56:59], s60 offen offset:3584 nt
buffer_load_dwordx2 v[146:147], v11, s[56:59], s61 offen offset:0 nt
buffer_load_dwordx2 v[148:149], v11, s[56:59], s61 offen offset:384 nt
buffer_load_dwordx2 v[150:151], v11, s[56:59], s61 offen offset:896 nt
buffer_load_dwordx2 v[152:153], v11, s[56:59], s61 offen offset:1280 nt
buffer_load_dwordx2 v[154:155], v11, s[56:59], s61 offen offset:1792 nt
buffer_load_dwordx2 v[156:157], v11, s[56:59], s61 offen offset:2176 nt
buffer_load_dwordx2 v[158:159], v11, s[56:59], s61 offen offset:2688 nt
buffer_load_dwordx2 v[160:161], v11, s[56:59], s61 offen offset:3072 nt
buffer_load_dwordx2 v[162:163], v11, s[56:59], s61 offen offset:3584 nt
buffer_load_dwordx2 v[164:165], v11, s[56:59], s61 offen offset:3968 nt
buffer_load_dwordx2 v[166:167], v11, s[56:59], s62 offen offset:384 nt
buffer_load_dwordx2 v[168:169], v11, s[56:59], s62 offen offset:768 nt
buffer_load_dwordx2 v[170:171], v11, s[56:59], s62 offen offset:1280 nt
buffer_load_dwordx2 v[172:173], v11, s[56:59], s62 offen offset:1664 nt
buffer_load_dwordx2 v[174:175], v11, s[56:59], s62 offen offset:2176 nt
buffer_load_dwordx2 v[176:177], v11, s[56:59], s62 offen offset:2560 nt
buffer_load_dwordx2 v[178:179], v11, s[56:59], s62 offen offset:3072 nt
buffer_load_dwordx2 v[180:181], v11, s[56:59], s62 offen offset:3456 nt
buffer_load_dwordx2 v[182:183], v11, s[56:59], s62 offen offset:3968 nt
buffer_load_dwordx2 v[184:185], v11, s[56:59], s63 offen offset:256 nt
buffer_load_dwordx2 v[186:187], v11, s[56:59], s63 offen offset:768 nt
buffer_load_dwordx2 v[188:189], v11, s[56:59], s63 offen offset:1152 nt
buffer_load_dwordx2 v[190:191], v11, s[56:59], s63 offen offset:1664 nt
s_waitcnt vmcnt(0)
buffer_load_dwordx4 v[64:67], v60, s[48:51], s74 offen sc1
buffer_load_dwordx4 v[68:71], v60, s[48:51], s74 offen offset:16 sc1
v_perm_b32 v192, v132, v128, s8
v_perm_b32 v193, v132, v128, s9
v_perm_b32 v194, v133, v129, s8
v_perm_b32 v195, v133, v129, s9
v_perm_b32 v196, v134, v130, s8
v_perm_b32 v197, v134, v130, s9
v_perm_b32 v198, v135, v131, s8
v_perm_b32 v199, v135, v131, s9
v_perm_b32 v200, v140, v136, s8
v_perm_b32 v201, v140, v136, s9
v_perm_b32 v202, v141, v137, s8
v_perm_b32 v203, v141, v137, s9
v_perm_b32 v204, v142, v138, s8
v_perm_b32 v205, v142, v138, s9
v_perm_b32 v206, v143, v139, s8
v_perm_b32 v207, v143, v139, s9
v_perm_b32 v208, v148, v144, s8
v_perm_b32 v209, v148, v144, s9
v_perm_b32 v210, v149, v145, s8
v_perm_b32 v211, v149, v145, s9
v_perm_b32 v212, v150, v146, s8
v_perm_b32 v213, v150, v146, s9
v_perm_b32 v214, v151, v147, s8
v_perm_b32 v215, v151, v147, s9
v_perm_b32 v216, v156, v152, s8
v_perm_b32 v217, v156, v152, s9
v_perm_b32 v218, v157, v153, s8
v_perm_b32 v219, v157, v153, s9
v_perm_b32 v220, v158, v154, s8
v_perm_b32 v221, v158, v154, s9
v_perm_b32 v222, v159, v155, s8
v_perm_b32 v223, v159, v155, s9
v_perm_b32 v224, v164, v160, s8
v_perm_b32 v225, v164, v160, s9
v_perm_b32 v226, v165, v161, s8
v_perm_b32 v227, v165, v161, s9
v_perm_b32 v228, v166, v162, s8
v_perm_b32 v229, v166, v162, s9
v_perm_b32 v230, v167, v163, s8
v_perm_b32 v231, v167, v163, s9
v_perm_b32 v232, v172, v168, s8
v_perm_b32 v233, v172, v168, s9
v_perm_b32 v234, v173, v169, s8
v_perm_b32 v235, v173, v169, s9
v_perm_b32 v236, v174, v170, s8
v_perm_b32 v237, v174, v170, s9
v_perm_b32 v238, v175, v171, s8
v_perm_b32 v239, v175, v171, s9
v_perm_b32 v240, v180, v176, s8
v_perm_b32 v241, v180, v176, s9
v_perm_b32 v242, v181, v177, s8
v_perm_b32 v243, v181, v177, s9
v_perm_b32 v244, v182, v178, s8
v_perm_b32 v245, v182, v178, s9
v_perm_b32 v246, v183, v179, s8
v_perm_b32 v247, v183, v179, s9
v_perm_b32 v248, v188, v184, s8
v_perm_b32 v249, v188, v184, s9
v_perm_b32 v250, v189, v185, s8
v_perm_b32 v251, v189, v185, s9
v_perm_b32 v252, v190, v186, s8
v_perm_b32 v253, v190, v186, s9
v_perm_b32 v254, v191, v187, s8
v_perm_b32 v255, v191, v187, s9
s_mov_b32 s71, 0
s_branch .LpollA_wait
.LstageA:
s_mov_b32 s71, 0
.LpollA:
buffer_load_dwordx4 v[64:67], v60, s[48:51], s74 offen sc1
buffer_load_dwordx4 v[68:71], v60, s[48:51], s74 offen offset:16 sc1
.LpollA_wait:
s_waitcnt vmcnt(0)
v_max_u32 v16, v64, v65
v_max3_u32 v16, v16, v66, v67
v_max3_u32 v16, v16, v68, v69
v_max3_u32 v16, v16, v70, v71
v_cmp_eq_u32 vcc, -1, v16
s_add_u32 s71, s71, 1
s_cbranch_vccz .LpollA_done
s_mov_b64 exec, vcc
s_bcnt1_i32_b64 s68, vcc
s_cmp_le_u32 s68, 16
s_cbranch_scc1 .LpollA_fast
s_sleep 8
.LpollA_fast:
s_cmp_lt_u32 s71, 100000
s_cbranch_scc1 .LpollA
.LpollA_done:
s_mov_b64 exec, -1
v_alignbit_b32 v19, v64, v19, 4
v_mov_b32 v24, 0
v_alignbit_b32 v19, v65, v19, 4
v_mov_b32 v25, 0
v_alignbit_b32 v19, v66, v19, 4
v_mov_b32 v26, 0
v_alignbit_b32 v19, v67, v19, 4
v_mov_b32 v27, 0
v_alignbit_b32 v19, v68, v19, 4
v_mov_b32 v28, 0
v_alignbit_b32 v19, v69, v19, 4
v_mov_b32 v29, 0
v_alignbit_b32 v19, v70, v19, 4
v_mov_b32 v30, 0
v_alignbit_b32 v19, v71, v19, 4
v_mov_b32 v31, 0
v_readfirstlane_b32 s68, v19
s_nop 1
v_subrev_f32 v16, s68, v19
v_cmp_nle_f32 vcc, v16, v61
s_cbranch_vccz .Lrefok
v_mov_b32 v16, v19
s_nop 1
v_max_f32_dpp v16, v16, v16 quad_perm:[2,3,0,1] row_mask:0xf bank_mask:0xf
s_nop 1
v_max_f32_dpp v16, v16, v16 row_ror:4 row_mask:0xf bank_mask:0xf
s_nop 1
v_max_f32_dpp v16, v16, v16 row_ror:8 row_mask:0xf bank_mask:0xf
v_mov_b32 v17, v16
s_nop 1
v_permlane16_swap_b32 v16, v17
s_nop 1
v_max_f32 v16, v16, v17
v_mov_b32 v17, v16
s_nop 1
v_permlane32_swap_b32 v16, v17
s_nop 1
v_max_f32 v16, v16, v17
v_sub_f32 v16, v19, v16
.Lrefok:
v_exp_f32 v16, v16
s_nop 0
v_mov_b32 v17, v16
v_mul_f32 v96, v16, v64
v_mul_f32 v97, v16, v65
v_mul_f32 v98, v16, v66
v_mul_f32 v99, v16, v67
v_mul_f32 v100, v16, v68
v_mul_f32 v101, v16, v69
v_mul_f32 v102, v16, v70
v_mul_f32 v103, v16, v71
v_mov_b32 v18, v17
v_permlane32_swap_b32 v96, v100
v_permlane32_swap_b32 v97, v101
v_permlane32_swap_b32 v98, v102
v_permlane32_swap_b32 v99, v103
v_permlane32_swap_b32 v17, v18
s_nop 1
v_add_f32 v96, v96, v100
v_add_f32 v97, v97, v101
v_add_f32 v98, v98, v102
v_add_f32 v99, v99, v103
v_add_f32 v17, v17, v18
v_mov_b32 v18, v17
v_permlane16_swap_b32 v96, v98
v_permlane16_swap_b32 v97, v99
v_permlane16_swap_b32 v17, v18
s_nop 1
v_add_f32 v96, v96, v98
v_add_f32 v97, v97, v99
v_add_f32 v17, v17, v18
s_nop 1
v_add_f32_dpp v17, v17, v17 quad_perm:[2,3,0,1] row_mask:0xf bank_mask:0xf
v_add_f32_dpp v96, v96, v96 quad_perm:[2,3,0,1] row_mask:0xf bank_mask:0xf
v_add_f32_dpp v97, v97, v97 quad_perm:[2,3,0,1] row_mask:0xf bank_mask:0xf
v_add_f32_dpp v17, v17, v17 row_ror:4 row_mask:0xf bank_mask:0xf
v_add_f32_dpp v96, v96, v96 row_ror:4 row_mask:0xf bank_mask:0xf
v_add_f32_dpp v97, v97, v97 row_ror:4 row_mask:0xf bank_mask:0xf
v_add_f32_dpp v17, v17, v17 row_ror:8 row_mask:0xf bank_mask:0xf
v_add_f32_dpp v96, v96, v96 row_ror:8 row_mask:0xf bank_mask:0xf
v_add_f32_dpp v97, v97, v97 row_ror:8 row_mask:0xf bank_mask:0xf
v_rcp_f32 v17, v17
s_nop 0
v_mul_f32 v96, v96, v17
v_mul_f32 v97, v97, v17
v_cvt_pk_bf16_f32 v16, v96, v97
s_nop 0
v_readlane_b32 s80, v16, 0
v_readlane_b32 s81, v16, 16
v_readlane_b32 s82, v16, 32
v_readlane_b32 s83, v16, 48
v_readlane_b32 s84, v16, 1
v_readlane_b32 s85, v16, 17
v_readlane_b32 s86, v16, 33
v_readlane_b32 s87, v16, 49
v_dot2c_f32_bf16 v24, s80, v192
v_dot2c_f32_bf16 v25, s80, v193
v_dot2c_f32_bf16 v26, s80, v194
v_dot2c_f32_bf16 v27, s80, v195
v_dot2c_f32_bf16 v24, s81, v200
v_dot2c_f32_bf16 v25, s81, v201
v_dot2c_f32_bf16 v26, s81, v202
v_dot2c_f32_bf16 v27, s81, v203
v_dot2c_f32_bf16 v24, s82, v208
v_dot2c_f32_bf16 v25, s82, v209
v_dot2c_f32_bf16 v26, s82, v210
v_dot2c_f32_bf16 v27, s82, v211
v_dot2c_f32_bf16 v24, s83, v216
v_dot2c_f32_bf16 v25, s83, v217
v_dot2c_f32_bf16 v26, s83, v218
v_dot2c_f32_bf16 v27, s83, v219
v_dot2c_f32_bf16 v24, s84, v224
v_dot2c_f32_bf16 v25, s84, v225
v_dot2c_f32_bf16 v26, s84, v226
v_dot2c_f32_bf16 v27, s84, v227
v_dot2c_f32_bf16 v24, s85, v232
v_dot2c_f32_bf16 v25, s85, v233
v_dot2c_f32_bf16 v26, s85, v234
v_dot2c_f32_bf16 v27, s85, v235
v_dot2c_f32_bf16 v24, s86, v240
v_dot2c_f32_bf16 v25, s86, v241
v_dot2c_f32_bf16 v26, s86, v242
v_dot2c_f32_bf16 v27, s86, v243
v_dot2c_f32_bf16 v24, s87, v248
v_dot2c_f32_bf16 v25, s87, v249
v_dot2c_f32_bf16 v26, s87, v250
v_dot2c_f32_bf16 v27, s87, v251
v_min_u32 v24, -2, v24
v_min_u32 v25, -2, v25
v_min_u32 v26, -2, v26
v_min_u32 v27, -2, v27
buffer_store_dwordx4 v[24:27], v62, s[48:51], s77 offen sc1
v_dot2c_f32_bf16 v28, s80, v196
v_dot2c_f32_bf16 v29, s80, v197
v_dot2c_f32_bf16 v30, s80, v198
v_dot2c_f32_bf16 v31, s80, v199
v_dot2c_f32_bf16 v28, s81, v204
v_dot2c_f32_bf16 v29, s81, v205
v_dot2c_f32_bf16 v30, s81, v206
v_dot2c_f32_bf16 v31, s81, v207
v_dot2c_f32_bf16 v28, s82, v212
v_dot2c_f32_bf16 v29, s82, v213
v_dot2c_f32_bf16 v30, s82, v214
v_dot2c_f32_bf16 v31, s82, v215
v_dot2c_f32_bf16 v28, s83, v220
v_dot2c_f32_bf16 v29, s83, v221
v_dot2c_f32_bf16 v30, s83, v222
v_dot2c_f32_bf16 v31, s83, v223
v_dot2c_f32_bf16 v28, s84, v228
v_dot2c_f32_bf16 v29, s84, v229
v_dot2c_f32_bf16 v30, s84, v230
v_dot2c_f32_bf16 v31, s84, v231
v_dot2c_f32_bf16 v28, s85, v236
v_dot2c_f32_bf16 v29, s85, v237
v_dot2c_f32_bf16 v30, s85, v238
v_dot2c_f32_bf16 v31, s85, v239
v_dot2c_f32_bf16 v28, s86, v244
v_dot2c_f32_bf16 v29, s86, v245
v_dot2c_f32_bf16 v30, s86, v246
v_dot2c_f32_bf16 v31, s86, v247
v_dot2c_f32_bf16 v28, s87, v252
v_dot2c_f32_bf16 v29, s87, v253
v_dot2c_f32_bf16 v30, s87, v254
v_dot2c_f32_bf16 v31, s87, v255
v_min_u32 v28, -2, v28
v_min_u32 v29, -2, v29
v_min_u32 v30, -2, v30
v_min_u32 v31, -2, v31
buffer_store_dwordx4 v[28:31], v63, s[48:51], s77 offen sc1
.Lhend:
s_cmp_eq_u32 s2, 0
s_cselect_b32 s68, 0, 0x10000000
s_mov_b64 exec, 1
buffer_store_dword v9, v9, s[52:55], s68 offen sc1
s_mov_b64 exec, -1
.Ldone:
s_endpgm
.section .rodata,"a"
.p2align 6
.amdhsa_kernel parallel_sum__gqa_block_cached__swiglu_ffn__decode_kernel
  .amdhsa_next_free_vgpr 256
  .amdhsa_next_free_sgpr 102
  .amdhsa_accum_offset 256
  .amdhsa_group_segment_fixed_size 0
  .amdhsa_kernarg_size 96
  .amdhsa_user_sgpr_count 2
  .amdhsa_user_sgpr_kernarg_segment_ptr 1
  .amdhsa_system_sgpr_workgroup_id_x 1
.end_amdhsa_kernel
```
